```python
import torch

def _softmax(x, axis=-1):
    return torch.softmax(x, dim=axis)
def _gelu(x):
    return torch.nn.functional.gelu(x, approximate="tanh")
def _silu(x):
    return torch.nn.functional.silu(x)
def _sigmoid(x):
    return torch.sigmoid(x)
def _layernorm(x, axis=-1, eps=1e-5):
    m = x.mean(dim=axis, keepdim=True)
    v = x.var(dim=axis, keepdim=True, unbiased=False)
    return (x - m) / torch.sqrt(v + eps)
def _scatter_add(tgt, idx, src, axis=0):
    return tgt.clone().index_add_(axis, idx, src)
def _segment_sum(src, seg, n):
    out = torch.zeros((n,) + src.shape[1:], dtype=src.dtype)
    return out.index_add_(0, seg, src)
def _pad(x, pw):
    flat = tuple(v for pair in reversed(pw) for v in pair)
    return torch.nn.functional.pad(x, flat)

kernel_name = 'recurrent_scan__ssm_conv_h3__glu_gated_swiglu__prompt'

def setup_inputs():

    _w = (lambda a: (lambda t: t.to(torch.bfloat16) if t.is_floating_point() else t)(torch.as_tensor(a)))
    def _A_setup():
        B, S, D = 1, 2048, 448
        ks = 4
        return {
            "q": _w((lambda *s: torch.randn(*s, dtype=torch.bfloat16) * 0.05)(B, S, D)),
            "k": _w((lambda *s: torch.randn(*s, dtype=torch.bfloat16) * 0.8)(B, S, D)),
            "v": _w((lambda *s: torch.randn(*s, dtype=torch.bfloat16) * 0.8)(B, S, D)),
            "shift_k": _w((lambda *s: torch.randn(*s, dtype=torch.bfloat16) * 0.8)(D, ks) * 0.5),
            "ssm_k": _w((lambda *s: torch.randn(*s, dtype=torch.bfloat16) * 0.8)(D, S) * (1.0 / S ** 0.5)),
            "ssm_D": _w((lambda *s: torch.randn(*s, dtype=torch.bfloat16) * 0.8)(D)),
        }
    _A_in = _A_setup()

    def _B_setup():
        B, S, D, F = 1, 2048, 448, 1792
        return {
            "x": _w((lambda *s: torch.randn(*s, dtype=torch.bfloat16) * 0.05)(B, S, D)),
            "w1": _w((lambda *s: torch.randn(*s, dtype=torch.bfloat16) * 0.2)(D, F) * (2.0 / D) ** 0.5),
            "w3": _w((lambda *s: torch.randn(*s, dtype=torch.bfloat16) * 0.2)(D, F) * (2.0 / D) ** 0.5),
            "w2": _w((lambda *s: torch.randn(*s, dtype=torch.bfloat16) * 0.2)(F, D) * (2.0 / F) ** 0.5),
        }
    _B_in = _B_setup()

    return {
        "A_q": _A_in["q"],
        "A_k": _A_in["k"],
        "A_v": _A_in["v"],
        "A_shift_k": _A_in["shift_k"],
        "A_ssm_k": _A_in["ssm_k"],
        "A_ssm_D": _A_in["ssm_D"],
        "B_x": _B_in["x"],
        "B_w1": _B_in["w1"],
        "B_w3": _B_in["w3"],
        "B_w2": _B_in["w2"],
    }

def reference(A_q, A_k, A_v, A_shift_k, A_ssm_k, A_ssm_D, B_x, B_w1, B_w3, B_w2):
    def _A_ref(q, k, v, shift_k, ssm_k, ssm_D):
        B, S, D = q.shape
        ks = shift_k.shape[-1]
        k_pad = _pad(k, ((0, 0), (ks - 1, 0), (0, 0)))
        k_shift = torch.zeros_like(k)
        for t in range(ks):
            k_shift = k_shift + k_pad[:, t:t + S, :] * shift_k[:, ks - 1 - t][None, None, :]
        kv = k_shift * v
        L = 2 * S
        kv_pad = _pad(kv, ((0, 0), (0, S), (0, 0)))
        kf_pad = _pad(ssm_k, ((0, 0), (0, S)))
        kv_f = (lambda x, axes=(-2,-1): torch.fft.rfft2(x.float(), dim=axes))(kv_pad[:, None, :, :], axes=(1, 2))
        kf_f = (lambda x, axes=(-2,-1): torch.fft.rfft2(x.float(), dim=axes))(kf_pad[:, None, :], axes=(1, 2))
        kf_f = (lambda x, *d: x.permute(*d))(kf_f, 1, 2, 0)
        y_f = kv_f * kf_f[None, :, :, :]
        y = (lambda x, s, axes=(-2,-1): torch.fft.irfft2(x, s=s, dim=axes).to(torch.bfloat16))(y_f, (1, L), axes=(1, 2))[:, 0, :S, :]
        y = y + kv * ssm_D[None, None, :]
        return q * y

    def _B_ref(x, w1, w3, w2):
        gate = torch.einsum("bsd,df->bsf", x, w1)
        up = torch.einsum("bsd,df->bsf", x, w3)
        h = _silu(gate) * up
        out = torch.einsum("bsf,fd->bsd", h, w2)
        return out

    x = A_q
    xn = _layernorm(x, axis=-1)
    s = _A_ref(xn, A_k, A_v, A_shift_k, A_ssm_k, A_ssm_D)
    g = _silu(_B_ref(xn, B_w1, B_w3, B_w2))
    return x + s * g
```

```asm
; @launch grid=(256,1,1) block=(512,1,1) lds=163840
.amdgcn_target "amdgcn-amd-amdhsa--gfx950"
.text
.globl recurrent_scan__ssm_conv_h3__glu_gated_swiglu__prompt_kernel
.p2align 8
.type recurrent_scan__ssm_conv_h3__glu_gated_swiglu__prompt_kernel,@function
recurrent_scan__ssm_conv_h3__glu_gated_swiglu__prompt_kernel:
    s_getpc_b64 s[40:41]
    s_cmp_ge_u32 s2, 256
    s_cbranch_scc1 L_END
    s_load_dwordx16 s[64:79], s[0:1], 0
    s_load_dwordx8 s[80:87], s[0:1], 64
    s_load_dwordx2 s[88:89], s[0:1], 96
    s_and_b32 s41, s41, 0xffff
    s_mov_b32 s42, L_CODE_END-recurrent_scan__ssm_conv_h3__glu_gated_swiglu__prompt_kernel-64
    s_mov_b32 s43, 0x20000
    v_lshlrev_b32 v2, 7, v0
    buffer_load_dword v255, v2, s[40:43], 0 offen
    v_and_b32 v1, 63, v0
    v_lshrrev_b32 v2, 6, v0
    s_nop 0
    v_readfirstlane_b32 s44, v2
    s_cmp_lt_u32 s2, 32
    s_cbranch_scc1 L_SERVICE
    s_sub_u32 s49, s2, 32
    s_and_b32 s57, s49, 7
    s_lshr_b32 s58, s49, 3
    s_mul_i32 s59, s58, 37
    s_lshr_b32 s59, s59, 8
    s_mul_i32 s60, s59, 7
    s_sub_u32 s48, s58, s60
    s_lshr_b32 s45, s57, 1
    s_lshl_b32 s45, s45, 2
    s_add_u32 s45, s45, s59
    s_and_b32 s46, s57, 1
    s_mul_i32 s46, s46, 7
    s_add_u32 s46, s46, s48
    s_lshl_b32 s47, s57, 2
    s_add_u32 s47, s47, s59
    s_mul_i32 s60, s57, 28
    s_add_u32 s60, s60, s58
    s_and_b32 s50, s44, 1
    v_mov_b32 v2, 0
    v_lshlrev_b32 v3, 2, v1
    v_add_u32 v3, 163584, v3
    ds_write_b32 v3, v2
    s_cmp_lt_u32 s44, 4
    s_cbranch_scc1 L_ROLE_M
    s_cmp_ge_u32 s44, 6
    s_cbranch_scc1 L_ROLE_A
    s_setprio 1
    v_lshrrev_b32 v2, 2, v1
    v_lshrrev_b32 v3, 4, v1
    v_xor_b32 v4, v1, v3
    v_and_b32 v4, 3, v4
    s_lshl_b32 s57, s45, 7
    s_lshl_b32 s58, s50, 6
    s_add_u32 s57, s57, s58
    v_add_u32 v2, s57, v2
    v_mul_u32_u24 v2, 896, v2
    v_lshl_add_u32 v16, v4, 4, v2
    v_bfe_u32 v5, v1, 1, 3
    v_xor_b32 v5, v5, v3
    v_and_b32 v6, 1, v1
    v_lshl_or_b32 v5, v5, 1, v6
    s_lshl_b32 s57, s50, 4
    v_add_u32 v6, s57, v3
    v_mul_u32_u24 v6, 3584, v6
    s_lshl_b32 s57, s46, 8
    v_lshl_add_u32 v5, v5, 4, v6
    v_add_u32 v17, s57, v5
    v_xor_b32 v18, 128, v17
    s_mul_i32 s57, s59, 7
    s_lshr_b32 s57, s57, 1
    s_lshl_b32 s58, s48, 1
    s_add_u32 s57, s57, s58
    s_lshr_b32 s58, s45, 2
    s_add_u32 s57, s57, s58
    s_sub_u32 s58, s57, 14
    s_cmp_ge_u32 s57, 14
    s_cselect_b32 s57, s58, s57
    s_sub_u32 s58, s57, 14
    s_cmp_ge_u32 s57, 14
    s_cselect_b32 s57, s58, s57
    s_lshl_b32 s55, s57, 6
    s_mul_i32 s56, s57, 114688
    s_waitcnt lgkmcnt(0)
    s_lshl_b32 s76, s50, 12
    s_mov_b32 s4, s64
    s_and_b32 s5, s65, 0xffff
    s_mov_b32 s6, 1835008
    s_mov_b32 s7, 0x20000
    s_mov_b32 s32, s78
    s_and_b32 s33, s79, 0xffff
    s_mov_b32 s34, 1605632
    s_mov_b32 s35, 0x20000
    s_mov_b32 s36, s80
    s_and_b32 s37, s81, 0xffff
    s_mov_b32 s38, 1605632
    s_mov_b32 s39, 0x20000
    s_add_u32 m0, s76, 0
    s_add_u32 s57, s55, 0
    buffer_load_dwordx4 v16, s[4:7], s57 offen lds
    s_add_u32 m0, s76, 1024
    s_add_u32 s57, s55, 14336
    buffer_load_dwordx4 v16, s[4:7], s57 offen lds
    s_add_u32 m0, s76, 2048
    s_add_u32 s57, s55, 28672
    buffer_load_dwordx4 v16, s[4:7], s57 offen lds
    s_add_u32 m0, s76, 3072
    s_add_u32 s57, s55, 43008
    buffer_load_dwordx4 v16, s[4:7], s57 offen lds
    s_add_u32 m0, s76, 8192
    s_add_u32 s57, s56, 0
    buffer_load_dwordx4 v17, s[32:35], s57 offen lds
    s_add_u32 m0, s76, 9216
    s_add_u32 s57, s56, 14336
    buffer_load_dwordx4 v17, s[32:35], s57 offen lds
    s_add_u32 m0, s76, 10240
    s_add_u32 s57, s56, 28672
    buffer_load_dwordx4 v17, s[32:35], s57 offen lds
    s_add_u32 m0, s76, 11264
    s_add_u32 s57, s56, 43008
    buffer_load_dwordx4 v17, s[32:35], s57 offen lds
    s_add_u32 m0, s76, 16384
    s_add_u32 s57, s56, 0
    buffer_load_dwordx4 v18, s[36:39], s57 offen lds
    s_add_u32 m0, s76, 17408
    s_add_u32 s57, s56, 14336
    buffer_load_dwordx4 v18, s[36:39], s57 offen lds
    s_add_u32 m0, s76, 18432
    s_add_u32 s57, s56, 28672
    buffer_load_dwordx4 v18, s[36:39], s57 offen lds
    s_add_u32 m0, s76, 19456
    s_add_u32 s57, s56, 43008
    buffer_load_dwordx4 v18, s[36:39], s57 offen lds
    s_add_u32 s55, s55, 64
    s_add_u32 s56, s56, 114688
    s_cmp_ge_u32 s55, 896
    s_cselect_b32 s55, 0, s55
    s_cselect_b32 s56, 0, s56
    s_add_u32 m0, s76, 24576
    s_add_u32 s57, s55, 0
    buffer_load_dwordx4 v16, s[4:7], s57 offen lds
    s_add_u32 m0, s76, 25600
    s_add_u32 s57, s55, 14336
    buffer_load_dwordx4 v16, s[4:7], s57 offen lds
    s_add_u32 m0, s76, 26624
    s_add_u32 s57, s55, 28672
    buffer_load_dwordx4 v16, s[4:7], s57 offen lds
    s_add_u32 m0, s76, 27648
    s_add_u32 s57, s55, 43008
    buffer_load_dwordx4 v16, s[4:7], s57 offen lds
    s_add_u32 m0, s76, 32768
    s_add_u32 s57, s56, 0
    buffer_load_dwordx4 v17, s[32:35], s57 offen lds
    s_add_u32 m0, s76, 33792
    s_add_u32 s57, s56, 14336
    buffer_load_dwordx4 v17, s[32:35], s57 offen lds
    s_add_u32 m0, s76, 34816
    s_add_u32 s57, s56, 28672
    buffer_load_dwordx4 v17, s[32:35], s57 offen lds
    s_add_u32 m0, s76, 35840
    s_add_u32 s57, s56, 43008
    buffer_load_dwordx4 v17, s[32:35], s57 offen lds
    s_add_u32 m0, s76, 40960
    s_add_u32 s57, s56, 0
    buffer_load_dwordx4 v18, s[36:39], s57 offen lds
    s_add_u32 m0, s76, 41984
    s_add_u32 s57, s56, 14336
    buffer_load_dwordx4 v18, s[36:39], s57 offen lds
    s_add_u32 m0, s76, 43008
    s_add_u32 s57, s56, 28672
    buffer_load_dwordx4 v18, s[36:39], s57 offen lds
    s_add_u32 m0, s76, 44032
    s_add_u32 s57, s56, 43008
    buffer_load_dwordx4 v18, s[36:39], s57 offen lds
    s_add_u32 s55, s55, 64
    s_add_u32 s56, s56, 114688
    s_cmp_ge_u32 s55, 896
    s_cselect_b32 s55, 0, s55
    s_cselect_b32 s56, 0, s56
    s_sub_u32 s51, s44, 4
    s_lshl_b32 s66, s51, 11
    s_lshl_b32 s57, s60, 2
    s_load_dword s61, s[74:75], s57
    s_mov_b32 s4, s64
    s_and_b32 s5, s65, 0xffff
    s_mov_b32 s6, 1835008
    s_mov_b32 s7, 0x20000
    s_mov_b32 s12, s82
    s_and_b32 s13, s83, 0xffff
    s_mov_b32 s14, 1605632
    s_mov_b32 s15, 0x20000
    s_mov_b32 s16, s88
    s_and_b32 s17, s89, 0xffff
    s_mov_b32 s18, 25165824
    s_mov_b32 s19, 0x20000
    s_mov_b32 s20, s84
    s_and_b32 s21, s85, 0xffff
    s_mov_b32 s22, 1835008
    s_mov_b32 s23, 0x20000
    s_mov_b32 s24, s86
    s_and_b32 s25, s87, 0xffff
    s_mov_b32 s26, 256
    s_mov_b32 s27, 0x20000
    s_mov_b32 s28, s72
    s_and_b32 s29, s73, 0xffff
    s_mov_b32 s30, 1835008
    s_mov_b32 s31, 0x20000
    s_mov_b32 s40, s70
    s_and_b32 s41, s71, 0xffff
    s_mov_b32 s42, 3584
    s_mov_b32 s43, 0x20000
    s_mov_b32 s73, s59
    s_mov_b32 s70, s60
    s_bfe_u32 s53, s44, 0x10001
    v_lshlrev_b32 v22, 4, v1
    v_lshlrev_b32 v31, 6, v1
    v_lshlrev_b32 v29, 2, v1
    v_lshrrev_b32 v2, 3, v1
    v_bfe_u32 v4, v1, 4, 1
    v_and_b32 v5, 7, v1
    v_lshlrev_b32 v4, 2, v4
    v_xor_b32 v5, v5, v4
    v_mul_u32_u24 v2, 896, v2
    v_lshl_add_u32 v2, v5, 4, v2
    s_lshl_b32 s57, s48, 7
    v_add_u32 v9, s57, v2
    s_mul_i32 s57, s44, 200704
    v_add_u32 v24, s57, v9
    v_lshrrev_b32 v3, 5, v1
    v_bfe_u32 v2, v1, 4, 1
    v_bfe_u32 v4, v1, 2, 2
    v_and_b32 v5, 3, v1
    v_lshrrev_b32 v6, 1, v4
    v_lshlrev_b32 v7, 5, v2
    v_lshl_add_u32 v7, v5, 3, v7
    v_lshl_add_u32 v7, v4, 7, v7
    v_lshl_add_u32 v8, v6, 6, v7
    v_lshl_add_u32 v8, v3, 9, v8
    v_add_u32 v25, s66, v8
    v_xor_b32 v26, 64, v25
    s_mul_i32 s68, s47, 224
    s_mul_i32 s57, s44, 14
    s_add_u32 s68, s68, s57
    s_lshl_b32 s68, s68, 10
    s_add_u32 s68, s68, 4194304
    s_add_u32 s69, s68, 114688
    s_lshl_b32 s57, s48, 1
    s_lshl_b32 s58, s73, 2
    s_add_u32 s57, s57, s58
    s_sub_u32 s58, s57, 14
    s_cmp_ge_u32 s57, 14
    s_cselect_b32 s57, s58, s57
    s_mul_i32 s71, s57, 14336
    s_lshl_b32 s72, s57, 10
    s_waitcnt lgkmcnt(0)
    s_lshl_b32 s57, s61, 16
    s_and_b32 s58, s61, 0xffff0000
    s_cmp_eq_u32 s53, 0
    s_cselect_b32 s61, s57, s58
    v_add_u32 v20, 131072, v25
    v_add_u32 v21, 131072, v26
    s_mul_i32 s57, s50, 401408
    v_add_u32 v19, s57, v9
    s_mov_b32 s52, s71
    s_mul_i32 s77, s50, 12288
    s_add_u32 s77, s77, 24576
    s_waitcnt vmcnt(12)
    s_barrier
    s_add_u32 m0, s76, 49152
    s_add_u32 s57, s55, 0
    buffer_load_dwordx4 v16, s[4:7], s57 offen lds
    s_add_u32 m0, s76, 50176
    s_add_u32 s57, s55, 14336
    buffer_load_dwordx4 v16, s[4:7], s57 offen lds
    s_add_u32 m0, s76, 51200
    s_add_u32 s57, s55, 28672
    buffer_load_dwordx4 v16, s[4:7], s57 offen lds
    s_add_u32 m0, s76, 52224
    s_add_u32 s57, s55, 43008
    buffer_load_dwordx4 v16, s[4:7], s57 offen lds
    s_add_u32 m0, s76, 57344
    s_add_u32 s57, s56, 0
    buffer_load_dwordx4 v17, s[32:35], s57 offen lds
    s_add_u32 m0, s76, 58368
    s_add_u32 s57, s56, 14336
    buffer_load_dwordx4 v17, s[32:35], s57 offen lds
    s_add_u32 m0, s76, 59392
    s_add_u32 s57, s56, 28672
    buffer_load_dwordx4 v17, s[32:35], s57 offen lds
    s_add_u32 m0, s76, 60416
    s_add_u32 s57, s56, 43008
    buffer_load_dwordx4 v17, s[32:35], s57 offen lds
    s_add_u32 m0, s76, 65536
    s_add_u32 s57, s56, 0
    buffer_load_dwordx4 v18, s[36:39], s57 offen lds
    s_add_u32 m0, s76, 66560
    s_add_u32 s57, s56, 14336
    buffer_load_dwordx4 v18, s[36:39], s57 offen lds
    s_add_u32 m0, s76, 67584
    s_add_u32 s57, s56, 28672
    buffer_load_dwordx4 v18, s[36:39], s57 offen lds
    s_add_u32 m0, s76, 68608
    s_add_u32 s57, s56, 43008
    buffer_load_dwordx4 v18, s[36:39], s57 offen lds
    s_add_u32 s55, s55, 64
    s_add_u32 s56, s56, 114688
    s_cmp_ge_u32 s55, 896
    s_cselect_b32 s55, 0, s55
    s_cselect_b32 s56, 0, s56
    s_waitcnt vmcnt(12)
    s_barrier
    s_add_u32 m0, s76, 73728
    s_add_u32 s57, s55, 0
    buffer_load_dwordx4 v16, s[4:7], s57 offen lds
    s_add_u32 m0, s76, 74752
    s_add_u32 s57, s55, 14336
    buffer_load_dwordx4 v16, s[4:7], s57 offen lds
    s_add_u32 m0, s76, 75776
    s_add_u32 s57, s55, 28672
    buffer_load_dwordx4 v16, s[4:7], s57 offen lds
    s_add_u32 m0, s76, 76800
    s_add_u32 s57, s55, 43008
    buffer_load_dwordx4 v16, s[4:7], s57 offen lds
    s_add_u32 m0, s76, 81920
    s_add_u32 s57, s56, 0
    buffer_load_dwordx4 v17, s[32:35], s57 offen lds
    s_add_u32 m0, s76, 82944
    s_add_u32 s57, s56, 14336
    buffer_load_dwordx4 v17, s[32:35], s57 offen lds
    s_add_u32 m0, s76, 83968
    s_add_u32 s57, s56, 28672
    buffer_load_dwordx4 v17, s[32:35], s57 offen lds
    s_add_u32 m0, s76, 84992
    s_add_u32 s57, s56, 43008
    buffer_load_dwordx4 v17, s[32:35], s57 offen lds
    s_add_u32 m0, s76, 90112
    s_add_u32 s57, s56, 0
    buffer_load_dwordx4 v18, s[36:39], s57 offen lds
    s_add_u32 m0, s76, 91136
    s_add_u32 s57, s56, 14336
    buffer_load_dwordx4 v18, s[36:39], s57 offen lds
    s_add_u32 m0, s76, 92160
    s_add_u32 s57, s56, 28672
    buffer_load_dwordx4 v18, s[36:39], s57 offen lds
    s_add_u32 m0, s76, 93184
    s_add_u32 s57, s56, 43008
    buffer_load_dwordx4 v18, s[36:39], s57 offen lds
    s_add_u32 s55, s55, 64
    s_add_u32 s56, s56, 114688
    s_cmp_ge_u32 s55, 896
    s_cselect_b32 s55, 0, s55
    s_cselect_b32 s56, 0, s56
    s_add_u32 m0, s76, 98304
    s_add_u32 s57, s55, 0
    buffer_load_dwordx4 v16, s[4:7], s57 offen lds
    s_add_u32 m0, s76, 99328
    s_add_u32 s57, s55, 14336
    buffer_load_dwordx4 v16, s[4:7], s57 offen lds
    s_add_u32 m0, s76, 100352
    s_add_u32 s57, s55, 28672
    buffer_load_dwordx4 v16, s[4:7], s57 offen lds
    s_add_u32 m0, s76, 101376
    s_add_u32 s57, s55, 43008
    buffer_load_dwordx4 v16, s[4:7], s57 offen lds
    s_add_u32 m0, s76, 106496
    s_add_u32 s57, s56, 0
    buffer_load_dwordx4 v17, s[32:35], s57 offen lds
    s_add_u32 m0, s76, 107520
    s_add_u32 s57, s56, 14336
    buffer_load_dwordx4 v17, s[32:35], s57 offen lds
    s_add_u32 m0, s76, 108544
    s_add_u32 s57, s56, 28672
    buffer_load_dwordx4 v17, s[32:35], s57 offen lds
    s_add_u32 m0, s76, 109568
    s_add_u32 s57, s56, 43008
    buffer_load_dwordx4 v17, s[32:35], s57 offen lds
    s_add_u32 m0, s76, 114688
    s_add_u32 s57, s56, 0
    buffer_load_dwordx4 v18, s[36:39], s57 offen lds
    s_add_u32 m0, s76, 115712
    s_add_u32 s57, s56, 14336
    buffer_load_dwordx4 v18, s[36:39], s57 offen lds
    s_add_u32 m0, s76, 116736
    s_add_u32 s57, s56, 28672
    buffer_load_dwordx4 v18, s[36:39], s57 offen lds
    s_add_u32 m0, s76, 117760
    s_add_u32 s57, s56, 43008
    buffer_load_dwordx4 v18, s[36:39], s57 offen lds
    s_add_u32 s55, s55, 64
    s_add_u32 s56, s56, 114688
    s_cmp_ge_u32 s55, 896
    s_cselect_b32 s55, 0, s55
    s_cselect_b32 s56, 0, s56
    s_waitcnt vmcnt(24)
    s_barrier
    s_add_u32 m0, s76, 0
    s_add_u32 s57, s55, 0
    buffer_load_dwordx4 v16, s[4:7], s57 offen lds
    s_add_u32 m0, s76, 1024
    s_add_u32 s57, s55, 14336
    buffer_load_dwordx4 v16, s[4:7], s57 offen lds
    s_add_u32 m0, s76, 2048
    s_add_u32 s57, s55, 28672
    buffer_load_dwordx4 v16, s[4:7], s57 offen lds
    s_add_u32 m0, s76, 3072
    s_add_u32 s57, s55, 43008
    buffer_load_dwordx4 v16, s[4:7], s57 offen lds
    s_add_u32 m0, s76, 8192
    s_add_u32 s57, s56, 0
    buffer_load_dwordx4 v17, s[32:35], s57 offen lds
    s_add_u32 m0, s76, 9216
    s_add_u32 s57, s56, 14336
    buffer_load_dwordx4 v17, s[32:35], s57 offen lds
    s_add_u32 m0, s76, 10240
    s_add_u32 s57, s56, 28672
    buffer_load_dwordx4 v17, s[32:35], s57 offen lds
    s_add_u32 m0, s76, 11264
    s_add_u32 s57, s56, 43008
    buffer_load_dwordx4 v17, s[32:35], s57 offen lds
    s_add_u32 m0, s76, 16384
    s_add_u32 s57, s56, 0
    buffer_load_dwordx4 v18, s[36:39], s57 offen lds
    s_add_u32 m0, s76, 17408
    s_add_u32 s57, s56, 14336
    buffer_load_dwordx4 v18, s[36:39], s57 offen lds
    s_add_u32 m0, s76, 18432
    s_add_u32 s57, s56, 28672
    buffer_load_dwordx4 v18, s[36:39], s57 offen lds
    s_add_u32 m0, s76, 19456
    s_add_u32 s57, s56, 43008
    buffer_load_dwordx4 v18, s[36:39], s57 offen lds
    s_add_u32 s55, s55, 64
    s_add_u32 s56, s56, 114688
    s_cmp_ge_u32 s55, 896
    s_cselect_b32 s55, 0, s55
    s_cselect_b32 s56, 0, s56
    s_waitcnt vmcnt(24)
    s_barrier
    s_add_u32 m0, s76, 24576
    s_add_u32 s57, s55, 0
    buffer_load_dwordx4 v16, s[4:7], s57 offen lds
    s_add_u32 m0, s76, 25600
    s_add_u32 s57, s55, 14336
    buffer_load_dwordx4 v16, s[4:7], s57 offen lds
    s_add_u32 m0, s76, 26624
    s_add_u32 s57, s55, 28672
    buffer_load_dwordx4 v16, s[4:7], s57 offen lds
    s_add_u32 m0, s76, 27648
    s_add_u32 s57, s55, 43008
    buffer_load_dwordx4 v16, s[4:7], s57 offen lds
    s_add_u32 m0, s76, 32768
    s_add_u32 s57, s56, 0
    buffer_load_dwordx4 v17, s[32:35], s57 offen lds
    s_add_u32 m0, s76, 33792
    s_add_u32 s57, s56, 14336
    buffer_load_dwordx4 v17, s[32:35], s57 offen lds
    s_add_u32 m0, s76, 34816
    s_add_u32 s57, s56, 28672
    buffer_load_dwordx4 v17, s[32:35], s57 offen lds
    s_add_u32 m0, s76, 35840
    s_add_u32 s57, s56, 43008
    buffer_load_dwordx4 v17, s[32:35], s57 offen lds
    s_add_u32 m0, s76, 40960
    s_add_u32 s57, s56, 0
    buffer_load_dwordx4 v18, s[36:39], s57 offen lds
    s_add_u32 m0, s76, 41984
    s_add_u32 s57, s56, 14336
    buffer_load_dwordx4 v18, s[36:39], s57 offen lds
    s_add_u32 m0, s76, 43008
    s_add_u32 s57, s56, 28672
    buffer_load_dwordx4 v18, s[36:39], s57 offen lds
    s_add_u32 m0, s76, 44032
    s_add_u32 s57, s56, 43008
    buffer_load_dwordx4 v18, s[36:39], s57 offen lds
    s_add_u32 s55, s55, 64
    s_add_u32 s56, s56, 114688
    s_cmp_ge_u32 s55, 896
    s_cselect_b32 s55, 0, s55
    s_cselect_b32 s56, 0, s56
    s_waitcnt vmcnt(24)
    s_barrier
    s_add_u32 m0, s76, 49152
    s_add_u32 s57, s55, 0
    buffer_load_dwordx4 v16, s[4:7], s57 offen lds
    s_add_u32 m0, s76, 50176
    s_add_u32 s57, s55, 14336
    buffer_load_dwordx4 v16, s[4:7], s57 offen lds
    s_add_u32 m0, s76, 51200
    s_add_u32 s57, s55, 28672
    buffer_load_dwordx4 v16, s[4:7], s57 offen lds
    s_add_u32 m0, s76, 52224
    s_add_u32 s57, s55, 43008
    buffer_load_dwordx4 v16, s[4:7], s57 offen lds
    s_add_u32 m0, s76, 57344
    s_add_u32 s57, s56, 0
    buffer_load_dwordx4 v17, s[32:35], s57 offen lds
    s_add_u32 m0, s76, 58368
    s_add_u32 s57, s56, 14336
    buffer_load_dwordx4 v17, s[32:35], s57 offen lds
    s_add_u32 m0, s76, 59392
    s_add_u32 s57, s56, 28672
    buffer_load_dwordx4 v17, s[32:35], s57 offen lds
    s_add_u32 m0, s76, 60416
    s_add_u32 s57, s56, 43008
    buffer_load_dwordx4 v17, s[32:35], s57 offen lds
    s_add_u32 m0, s76, 65536
    s_add_u32 s57, s56, 0
    buffer_load_dwordx4 v18, s[36:39], s57 offen lds
    s_add_u32 m0, s76, 66560
    s_add_u32 s57, s56, 14336
    buffer_load_dwordx4 v18, s[36:39], s57 offen lds
    s_add_u32 m0, s76, 67584
    s_add_u32 s57, s56, 28672
    buffer_load_dwordx4 v18, s[36:39], s57 offen lds
    s_add_u32 m0, s76, 68608
    s_add_u32 s57, s56, 43008
    buffer_load_dwordx4 v18, s[36:39], s57 offen lds
    s_add_u32 s55, s55, 64
    s_add_u32 s56, s56, 114688
    s_cmp_ge_u32 s55, 896
    s_cselect_b32 s55, 0, s55
    s_cselect_b32 s56, 0, s56
    s_waitcnt vmcnt(24)
    s_barrier
    s_add_u32 m0, s76, 73728
    s_add_u32 s57, s55, 0
    buffer_load_dwordx4 v16, s[4:7], s57 offen lds
    s_add_u32 m0, s76, 74752
    s_add_u32 s57, s55, 14336
    buffer_load_dwordx4 v16, s[4:7], s57 offen lds
    s_add_u32 m0, s76, 75776
    s_add_u32 s57, s55, 28672
    buffer_load_dwordx4 v16, s[4:7], s57 offen lds
    s_add_u32 m0, s76, 76800
    s_add_u32 s57, s55, 43008
    buffer_load_dwordx4 v16, s[4:7], s57 offen lds
    s_add_u32 m0, s76, 81920
    s_add_u32 s57, s56, 0
    buffer_load_dwordx4 v17, s[32:35], s57 offen lds
    s_add_u32 m0, s76, 82944
    s_add_u32 s57, s56, 14336
    buffer_load_dwordx4 v17, s[32:35], s57 offen lds
    s_add_u32 m0, s76, 83968
    s_add_u32 s57, s56, 28672
    buffer_load_dwordx4 v17, s[32:35], s57 offen lds
    s_add_u32 m0, s76, 84992
    s_add_u32 s57, s56, 43008
    buffer_load_dwordx4 v17, s[32:35], s57 offen lds
    s_add_u32 m0, s76, 90112
    s_add_u32 s57, s56, 0
    buffer_load_dwordx4 v18, s[36:39], s57 offen lds
    s_add_u32 m0, s76, 91136
    s_add_u32 s57, s56, 14336
    buffer_load_dwordx4 v18, s[36:39], s57 offen lds
    s_add_u32 m0, s76, 92160
    s_add_u32 s57, s56, 28672
    buffer_load_dwordx4 v18, s[36:39], s57 offen lds
    s_add_u32 m0, s76, 93184
    s_add_u32 s57, s56, 43008
    buffer_load_dwordx4 v18, s[36:39], s57 offen lds
    s_add_u32 s55, s55, 64
    s_add_u32 s56, s56, 114688
    s_cmp_ge_u32 s55, 896
    s_cselect_b32 s55, 0, s55
    s_cselect_b32 s56, 0, s56
    s_waitcnt vmcnt(24)
    s_barrier
    s_add_u32 m0, s76, 98304
    s_add_u32 s57, s55, 0
    buffer_load_dwordx4 v16, s[4:7], s57 offen lds
    s_add_u32 m0, s76, 99328
    s_add_u32 s57, s55, 14336
    buffer_load_dwordx4 v16, s[4:7], s57 offen lds
    s_add_u32 m0, s76, 100352
    s_add_u32 s57, s55, 28672
    buffer_load_dwordx4 v16, s[4:7], s57 offen lds
    s_add_u32 m0, s76, 101376
    s_add_u32 s57, s55, 43008
    buffer_load_dwordx4 v16, s[4:7], s57 offen lds
    s_add_u32 m0, s76, 106496
    s_add_u32 s57, s56, 0
    buffer_load_dwordx4 v17, s[32:35], s57 offen lds
    s_add_u32 m0, s76, 107520
    s_add_u32 s57, s56, 14336
    buffer_load_dwordx4 v17, s[32:35], s57 offen lds
    s_add_u32 m0, s76, 108544
    s_add_u32 s57, s56, 28672
    buffer_load_dwordx4 v17, s[32:35], s57 offen lds
    s_add_u32 m0, s76, 109568
    s_add_u32 s57, s56, 43008
    buffer_load_dwordx4 v17, s[32:35], s57 offen lds
    s_add_u32 m0, s76, 114688
    s_add_u32 s57, s56, 0
    buffer_load_dwordx4 v18, s[36:39], s57 offen lds
    s_add_u32 m0, s76, 115712
    s_add_u32 s57, s56, 14336
    buffer_load_dwordx4 v18, s[36:39], s57 offen lds
    s_add_u32 m0, s76, 116736
    s_add_u32 s57, s56, 28672
    buffer_load_dwordx4 v18, s[36:39], s57 offen lds
    s_add_u32 m0, s76, 117760
    s_add_u32 s57, s56, 43008
    buffer_load_dwordx4 v18, s[36:39], s57 offen lds
    s_add_u32 s55, s55, 64
    s_add_u32 s56, s56, 114688
    s_cmp_ge_u32 s55, 896
    s_cselect_b32 s55, 0, s55
    s_cselect_b32 s56, 0, s56
    s_waitcnt vmcnt(24)
    s_barrier
    s_add_u32 m0, s76, 0
    s_add_u32 s57, s55, 0
    buffer_load_dwordx4 v16, s[4:7], s57 offen lds
    s_add_u32 m0, s76, 1024
    s_add_u32 s57, s55, 14336
    buffer_load_dwordx4 v16, s[4:7], s57 offen lds
    s_add_u32 m0, s76, 2048
    s_add_u32 s57, s55, 28672
    buffer_load_dwordx4 v16, s[4:7], s57 offen lds
    s_add_u32 m0, s76, 3072
    s_add_u32 s57, s55, 43008
    buffer_load_dwordx4 v16, s[4:7], s57 offen lds
    s_add_u32 m0, s76, 8192
    s_add_u32 s57, s56, 0
    buffer_load_dwordx4 v17, s[32:35], s57 offen lds
    s_add_u32 m0, s76, 9216
    s_add_u32 s57, s56, 14336
    buffer_load_dwordx4 v17, s[32:35], s57 offen lds
    s_add_u32 m0, s76, 10240
    s_add_u32 s57, s56, 28672
    buffer_load_dwordx4 v17, s[32:35], s57 offen lds
    s_add_u32 m0, s76, 11264
    s_add_u32 s57, s56, 43008
    buffer_load_dwordx4 v17, s[32:35], s57 offen lds
    s_add_u32 m0, s76, 16384
    s_add_u32 s57, s56, 0
    buffer_load_dwordx4 v18, s[36:39], s57 offen lds
    s_add_u32 m0, s76, 17408
    s_add_u32 s57, s56, 14336
    buffer_load_dwordx4 v18, s[36:39], s57 offen lds
    s_add_u32 m0, s76, 18432
    s_add_u32 s57, s56, 28672
    buffer_load_dwordx4 v18, s[36:39], s57 offen lds
    s_add_u32 m0, s76, 19456
    s_add_u32 s57, s56, 43008
    buffer_load_dwordx4 v18, s[36:39], s57 offen lds
    s_add_u32 s55, s55, 64
    s_add_u32 s56, s56, 114688
    s_cmp_ge_u32 s55, 896
    s_cselect_b32 s55, 0, s55
    s_cselect_b32 s56, 0, s56
    s_waitcnt vmcnt(24)
    s_barrier
    s_add_u32 m0, s76, 24576
    s_add_u32 s57, s55, 0
    buffer_load_dwordx4 v16, s[4:7], s57 offen lds
    s_add_u32 m0, s76, 25600
    s_add_u32 s57, s55, 14336
    buffer_load_dwordx4 v16, s[4:7], s57 offen lds
    s_add_u32 m0, s76, 26624
    s_add_u32 s57, s55, 28672
    buffer_load_dwordx4 v16, s[4:7], s57 offen lds
    s_add_u32 m0, s76, 27648
    s_add_u32 s57, s55, 43008
    buffer_load_dwordx4 v16, s[4:7], s57 offen lds
    s_add_u32 m0, s76, 32768
    s_add_u32 s57, s56, 0
    buffer_load_dwordx4 v17, s[32:35], s57 offen lds
    s_add_u32 m0, s76, 33792
    s_add_u32 s57, s56, 14336
    buffer_load_dwordx4 v17, s[32:35], s57 offen lds
    s_add_u32 m0, s76, 34816
    s_add_u32 s57, s56, 28672
    buffer_load_dwordx4 v17, s[32:35], s57 offen lds
    s_add_u32 m0, s76, 35840
    s_add_u32 s57, s56, 43008
    buffer_load_dwordx4 v17, s[32:35], s57 offen lds
    s_add_u32 m0, s76, 40960
    s_add_u32 s57, s56, 0
    buffer_load_dwordx4 v18, s[36:39], s57 offen lds
    s_add_u32 m0, s76, 41984
    s_add_u32 s57, s56, 14336
    buffer_load_dwordx4 v18, s[36:39], s57 offen lds
    s_add_u32 m0, s76, 43008
    s_add_u32 s57, s56, 28672
    buffer_load_dwordx4 v18, s[36:39], s57 offen lds
    s_add_u32 m0, s76, 44032
    s_add_u32 s57, s56, 43008
    buffer_load_dwordx4 v18, s[36:39], s57 offen lds
    s_add_u32 s55, s55, 64
    s_add_u32 s56, s56, 114688
    s_cmp_ge_u32 s55, 896
    s_cselect_b32 s55, 0, s55
    s_cselect_b32 s56, 0, s56
    s_waitcnt vmcnt(24)
    s_barrier
    s_add_u32 m0, s76, 49152
    s_add_u32 s57, s55, 0
    buffer_load_dwordx4 v16, s[4:7], s57 offen lds
    s_add_u32 m0, s76, 50176
    s_add_u32 s57, s55, 14336
    buffer_load_dwordx4 v16, s[4:7], s57 offen lds
    s_add_u32 m0, s76, 51200
    s_add_u32 s57, s55, 28672
    buffer_load_dwordx4 v16, s[4:7], s57 offen lds
    s_add_u32 m0, s76, 52224
    s_add_u32 s57, s55, 43008
    buffer_load_dwordx4 v16, s[4:7], s57 offen lds
    s_add_u32 m0, s76, 57344
    s_add_u32 s57, s56, 0
    buffer_load_dwordx4 v17, s[32:35], s57 offen lds
    s_add_u32 m0, s76, 58368
    s_add_u32 s57, s56, 14336
    buffer_load_dwordx4 v17, s[32:35], s57 offen lds
    s_add_u32 m0, s76, 59392
    s_add_u32 s57, s56, 28672
    buffer_load_dwordx4 v17, s[32:35], s57 offen lds
    s_add_u32 m0, s76, 60416
    s_add_u32 s57, s56, 43008
    buffer_load_dwordx4 v17, s[32:35], s57 offen lds
    s_add_u32 m0, s76, 65536
    s_add_u32 s57, s56, 0
    buffer_load_dwordx4 v18, s[36:39], s57 offen lds
    s_add_u32 m0, s76, 66560
    s_add_u32 s57, s56, 14336
    buffer_load_dwordx4 v18, s[36:39], s57 offen lds
    s_add_u32 m0, s76, 67584
    s_add_u32 s57, s56, 28672
    buffer_load_dwordx4 v18, s[36:39], s57 offen lds
    s_add_u32 m0, s76, 68608
    s_add_u32 s57, s56, 43008
    buffer_load_dwordx4 v18, s[36:39], s57 offen lds
    s_add_u32 s55, s55, 64
    s_add_u32 s56, s56, 114688
    s_cmp_ge_u32 s55, 896
    s_cselect_b32 s55, 0, s55
    s_cselect_b32 s56, 0, s56
    s_waitcnt vmcnt(24)
    s_barrier
    s_add_u32 m0, s76, 73728
    s_add_u32 s57, s55, 0
    buffer_load_dwordx4 v16, s[4:7], s57 offen lds
    s_add_u32 m0, s76, 74752
    s_add_u32 s57, s55, 14336
    buffer_load_dwordx4 v16, s[4:7], s57 offen lds
    s_add_u32 m0, s76, 75776
    s_add_u32 s57, s55, 28672
    buffer_load_dwordx4 v16, s[4:7], s57 offen lds
    s_add_u32 m0, s76, 76800
    s_add_u32 s57, s55, 43008
    buffer_load_dwordx4 v16, s[4:7], s57 offen lds
    s_add_u32 m0, s76, 81920
    s_add_u32 s57, s56, 0
    buffer_load_dwordx4 v17, s[32:35], s57 offen lds
    s_add_u32 m0, s76, 82944
    s_add_u32 s57, s56, 14336
    buffer_load_dwordx4 v17, s[32:35], s57 offen lds
    s_add_u32 m0, s76, 83968
    s_add_u32 s57, s56, 28672
    buffer_load_dwordx4 v17, s[32:35], s57 offen lds
    s_add_u32 m0, s76, 84992
    s_add_u32 s57, s56, 43008
    buffer_load_dwordx4 v17, s[32:35], s57 offen lds
    s_add_u32 m0, s76, 90112
    s_add_u32 s57, s56, 0
    buffer_load_dwordx4 v18, s[36:39], s57 offen lds
    s_add_u32 m0, s76, 91136
    s_add_u32 s57, s56, 14336
    buffer_load_dwordx4 v18, s[36:39], s57 offen lds
    s_add_u32 m0, s76, 92160
    s_add_u32 s57, s56, 28672
    buffer_load_dwordx4 v18, s[36:39], s57 offen lds
    s_add_u32 m0, s76, 93184
    s_add_u32 s57, s56, 43008
    buffer_load_dwordx4 v18, s[36:39], s57 offen lds
    s_add_u32 s55, s55, 64
    s_add_u32 s56, s56, 114688
    s_cmp_ge_u32 s55, 896
    s_cselect_b32 s55, 0, s55
    s_cselect_b32 s56, 0, s56
    s_waitcnt vmcnt(24)
    s_barrier
    s_add_u32 m0, s66, 140800
    s_add_u32 s57, s71, 7168
    buffer_load_dwordx4 v24, s[12:15], s71 offen lds
    s_add_u32 m0, s66, 141824
    s_add_u32 s71, s71, 14336
    buffer_load_dwordx4 v24, s[12:15], s57 offen lds
    s_cmp_ge_u32 s71, 200704
    s_cselect_b32 s71, 0, s71
    s_waitcnt vmcnt(2)
    s_barrier
    s_add_u32 m0, s66, 148992
    s_add_u32 s57, s71, 7168
    buffer_load_dwordx4 v24, s[12:15], s71 offen lds
    s_add_u32 m0, s66, 150016
    s_add_u32 s71, s71, 14336
    buffer_load_dwordx4 v24, s[12:15], s57 offen lds
    s_cmp_ge_u32 s71, 200704
    s_cselect_b32 s71, 0, s71
    s_add_u32 m0, s66, 0
    s_add_u32 s57, s71, 7168
    buffer_load_dwordx4 v24, s[12:15], s71 offen lds
    s_add_u32 m0, s66, 1024
    s_add_u32 s71, s71, 14336
    buffer_load_dwordx4 v24, s[12:15], s57 offen lds
    s_cmp_ge_u32 s71, 200704
    s_cselect_b32 s71, 0, s71
    s_add_u32 m0, s66, 8192
    s_add_u32 s57, s71, 7168
    buffer_load_dwordx4 v24, s[12:15], s71 offen lds
    s_add_u32 m0, s66, 9216
    s_add_u32 s71, s71, 14336
    buffer_load_dwordx4 v24, s[12:15], s57 offen lds
    s_cmp_ge_u32 s71, 200704
    s_cselect_b32 s71, 0, s71
    s_add_u32 m0, s66, 16384
    s_add_u32 s57, s71, 7168
    buffer_load_dwordx4 v24, s[12:15], s71 offen lds
    s_add_u32 m0, s66, 17408
    s_add_u32 s71, s71, 14336
    buffer_load_dwordx4 v24, s[12:15], s57 offen lds
    s_cmp_ge_u32 s71, 200704
    s_cselect_b32 s71, 0, s71
    s_waitcnt lgkmcnt(0)
    v_mov_b32 v2, 163760
    ds_read_b64 v[2:3], v2
    s_waitcnt lgkmcnt(0)
    v_readfirstlane_b32 s78, v2
    v_readfirstlane_b32 s79, v3
    s_nop 3
    s_mov_b32 s58, 0xf
    v_lshlrev_b32 v2, 2, v1
    v_add_u32 v2, 163600, v2
    v_min_u32 v2, 163836, v2
    s_mov_b32 s67, 0
L_LW_1:
    ds_read_b32 v3, v2
    s_waitcnt lgkmcnt(0)
    v_cmp_le_u32 vcc, 12, v3
    s_nop 3
    s_and_b32 s57, vcc_lo, s58
    s_cmp_eq_u32 s57, s58
    s_cbranch_scc1 L_LO_2
    s_sleep 1
    s_add_u32 s67, s67, 1
    s_cmp_lt_u32 s67, 800000
    s_cbranch_scc1 L_LW_1
L_LO_2:
    s_add_u32 m0, s77, 0
    s_add_u32 s57, s52, 0
    buffer_load_dwordx4 v19, s[12:15], s57 offen lds
    s_add_u32 m0, s77, 1024
    s_add_u32 s57, s52, 7168
    buffer_load_dwordx4 v19, s[12:15], s57 offen lds
    s_add_u32 m0, s77, 6144
    s_add_u32 s57, s52, 200704
    buffer_load_dwordx4 v19, s[12:15], s57 offen lds
    s_add_u32 m0, s77, 7168
    s_add_u32 s57, s52, 207872
    buffer_load_dwordx4 v19, s[12:15], s57 offen lds
    s_add_u32 s52, s52, 14336
    s_cmp_ge_u32 s52, 200704
    s_cselect_b32 s52, 0, s52
    s_add_u32 m0, s77, 2048
    s_add_u32 s57, s52, 0
    buffer_load_dwordx4 v19, s[12:15], s57 offen lds
    s_add_u32 m0, s77, 3072
    s_add_u32 s57, s52, 7168
    buffer_load_dwordx4 v19, s[12:15], s57 offen lds
    s_add_u32 m0, s77, 8192
    s_add_u32 s57, s52, 200704
    buffer_load_dwordx4 v19, s[12:15], s57 offen lds
    s_add_u32 m0, s77, 9216
    s_add_u32 s57, s52, 207872
    buffer_load_dwordx4 v19, s[12:15], s57 offen lds
    s_add_u32 s52, s52, 14336
    s_cmp_ge_u32 s52, 200704
    s_cselect_b32 s52, 0, s52
    s_add_u32 m0, s77, 4096
    s_add_u32 s57, s52, 0
    buffer_load_dwordx4 v19, s[12:15], s57 offen lds
    s_add_u32 m0, s77, 5120
    s_add_u32 s57, s52, 7168
    buffer_load_dwordx4 v19, s[12:15], s57 offen lds
    s_add_u32 m0, s77, 10240
    s_add_u32 s57, s52, 200704
    buffer_load_dwordx4 v19, s[12:15], s57 offen lds
    s_add_u32 m0, s77, 11264
    s_add_u32 s57, s52, 207872
    buffer_load_dwordx4 v19, s[12:15], s57 offen lds
    s_add_u32 s52, s52, 14336
    s_cmp_ge_u32 s52, 200704
    s_cselect_b32 s52, 0, s52
    s_waitcnt vmcnt(20)
    ds_read_b64_tr_b16 v[128:129], v20 offset:9728
    ds_read_b64_tr_b16 v[130:131], v20 offset:10752
    ds_read_b64_tr_b16 v[132:133], v21 offset:9728
    ds_read_b64_tr_b16 v[134:135], v21 offset:10752
    s_waitcnt lgkmcnt(0)
    s_add_u32 m0, s66, 140800
    s_add_u32 s57, s71, 7168
    buffer_load_dwordx4 v24, s[12:15], s71 offen lds
    s_add_u32 m0, s66, 141824
    s_add_u32 s71, s71, 14336
    buffer_load_dwordx4 v24, s[12:15], s57 offen lds
    s_cmp_ge_u32 s71, 200704
    s_cselect_b32 s71, 0, s71
    s_waitcnt vmcnt(20)
    ds_read_b64_tr_b16 v[136:137], v20 offset:17920
    ds_read_b64_tr_b16 v[138:139], v20 offset:18944
    ds_read_b64_tr_b16 v[140:141], v21 offset:17920
    ds_read_b64_tr_b16 v[142:143], v21 offset:18944
    s_waitcnt lgkmcnt(0)
    s_add_u32 m0, s66, 148992
    s_add_u32 s57, s71, 7168
    buffer_load_dwordx4 v24, s[12:15], s71 offen lds
    s_add_u32 m0, s66, 150016
    s_add_u32 s71, s71, 14336
    buffer_load_dwordx4 v24, s[12:15], s57 offen lds
    s_cmp_ge_u32 s71, 200704
    s_cselect_b32 s71, 0, s71
    s_waitcnt vmcnt(20)
    ds_read_b64_tr_b16 v[144:145], v25 offset:0
    ds_read_b64_tr_b16 v[146:147], v25 offset:1024
    ds_read_b64_tr_b16 v[148:149], v26 offset:0
    ds_read_b64_tr_b16 v[150:151], v26 offset:1024
    s_waitcnt lgkmcnt(0)
    s_add_u32 m0, s66, 0
    s_add_u32 s57, s71, 7168
    buffer_load_dwordx4 v24, s[12:15], s71 offen lds
    s_add_u32 m0, s66, 1024
    s_add_u32 s71, s71, 14336
    buffer_load_dwordx4 v24, s[12:15], s57 offen lds
    s_cmp_ge_u32 s71, 200704
    s_cselect_b32 s71, 0, s71
    s_mov_b32 s58, 0xf
    v_lshlrev_b32 v2, 2, v1
    v_add_u32 v2, 163600, v2
    v_min_u32 v2, 163836, v2
    s_mov_b32 s67, 0
L_LW_3:
    ds_read_b32 v3, v2
    s_waitcnt lgkmcnt(0)
    v_cmp_le_u32 vcc, 13, v3
    s_nop 3
    s_and_b32 s57, vcc_lo, s58
    s_cmp_eq_u32 s57, s58
    s_cbranch_scc1 L_LO_4
    s_sleep 1
    s_add_u32 s67, s67, 1
    s_cmp_lt_u32 s67, 800000
    s_cbranch_scc1 L_LW_3
L_LO_4:
    s_add_u32 m0, s77, 24576
    s_add_u32 s57, s52, 0
    buffer_load_dwordx4 v19, s[12:15], s57 offen lds
    s_add_u32 m0, s77, 25600
    s_add_u32 s57, s52, 7168
    buffer_load_dwordx4 v19, s[12:15], s57 offen lds
    s_add_u32 m0, s77, 30720
    s_add_u32 s57, s52, 200704
    buffer_load_dwordx4 v19, s[12:15], s57 offen lds
    s_add_u32 m0, s77, 31744
    s_add_u32 s57, s52, 207872
    buffer_load_dwordx4 v19, s[12:15], s57 offen lds
    s_add_u32 s52, s52, 14336
    s_cmp_ge_u32 s52, 200704
    s_cselect_b32 s52, 0, s52
    s_add_u32 m0, s77, 26624
    s_add_u32 s57, s52, 0
    buffer_load_dwordx4 v19, s[12:15], s57 offen lds
    s_add_u32 m0, s77, 27648
    s_add_u32 s57, s52, 7168
    buffer_load_dwordx4 v19, s[12:15], s57 offen lds
    s_add_u32 m0, s77, 32768
    s_add_u32 s57, s52, 200704
    buffer_load_dwordx4 v19, s[12:15], s57 offen lds
    s_add_u32 m0, s77, 33792
    s_add_u32 s57, s52, 207872
    buffer_load_dwordx4 v19, s[12:15], s57 offen lds
    s_add_u32 s52, s52, 14336
    s_cmp_ge_u32 s52, 200704
    s_cselect_b32 s52, 0, s52
    s_add_u32 m0, s77, 28672
    s_add_u32 s57, s52, 0
    buffer_load_dwordx4 v19, s[12:15], s57 offen lds
    s_add_u32 m0, s77, 29696
    s_add_u32 s57, s52, 7168
    buffer_load_dwordx4 v19, s[12:15], s57 offen lds
    s_add_u32 m0, s77, 34816
    s_add_u32 s57, s52, 200704
    buffer_load_dwordx4 v19, s[12:15], s57 offen lds
    s_add_u32 m0, s77, 35840
    s_add_u32 s57, s52, 207872
    buffer_load_dwordx4 v19, s[12:15], s57 offen lds
    s_add_u32 s52, s52, 14336
    s_cmp_ge_u32 s52, 200704
    s_cselect_b32 s52, 0, s52
    s_waitcnt vmcnt(32)
    ds_read_b64_tr_b16 v[152:153], v25 offset:8192
    ds_read_b64_tr_b16 v[154:155], v25 offset:9216
    ds_read_b64_tr_b16 v[156:157], v26 offset:8192
    ds_read_b64_tr_b16 v[158:159], v26 offset:9216
    s_waitcnt lgkmcnt(0)
    s_add_u32 m0, s66, 8192
    s_add_u32 s57, s71, 7168
    buffer_load_dwordx4 v24, s[12:15], s71 offen lds
    s_add_u32 m0, s66, 9216
    s_add_u32 s71, s71, 14336
    buffer_load_dwordx4 v24, s[12:15], s57 offen lds
    s_cmp_ge_u32 s71, 200704
    s_cselect_b32 s71, 0, s71
    s_waitcnt vmcnt(32)
    ds_read_b64_tr_b16 v[160:161], v25 offset:16384
    ds_read_b64_tr_b16 v[162:163], v25 offset:17408
    ds_read_b64_tr_b16 v[164:165], v26 offset:16384
    ds_read_b64_tr_b16 v[166:167], v26 offset:17408
    s_waitcnt vmcnt(18)
    ds_read_b64_tr_b16 v[168:169], v20 offset:9728
    ds_read_b64_tr_b16 v[170:171], v20 offset:10752
    ds_read_b64_tr_b16 v[172:173], v21 offset:9728
    ds_read_b64_tr_b16 v[174:175], v21 offset:10752
    s_waitcnt lgkmcnt(0)
    s_lshl_b32 s57, s50, 2
    s_add_u32 s57, s57, 163696
    v_mov_b32 v2, s57
    v_mov_b32 v3, 1
    s_mov_b64 exec, 1
    ds_write_b32 v2, v3
    s_mov_b64 exec, -1
    s_mov_b32 s58, 0xf
    v_lshlrev_b32 v2, 2, v1
    v_add_u32 v2, 163600, v2
    v_min_u32 v2, 163836, v2
    s_mov_b32 s67, 0
L_LW_5:
    ds_read_b32 v3, v2
    s_waitcnt lgkmcnt(0)
    v_cmp_le_u32 vcc, 14, v3
    s_nop 3
    s_and_b32 s57, vcc_lo, s58
    s_cmp_eq_u32 s57, s58
    s_cbranch_scc1 L_LO_6
    s_sleep 1
    s_add_u32 s67, s67, 1
    s_cmp_lt_u32 s67, 800000
    s_cbranch_scc1 L_LW_5
L_LO_6:
    s_add_u32 m0, s77, 49152
    s_add_u32 s57, s52, 0
    buffer_load_dwordx4 v19, s[12:15], s57 offen lds
    s_add_u32 m0, s77, 50176
    s_add_u32 s57, s52, 7168
    buffer_load_dwordx4 v19, s[12:15], s57 offen lds
    s_add_u32 m0, s77, 55296
    s_add_u32 s57, s52, 200704
    buffer_load_dwordx4 v19, s[12:15], s57 offen lds
    s_add_u32 m0, s77, 56320
    s_add_u32 s57, s52, 207872
    buffer_load_dwordx4 v19, s[12:15], s57 offen lds
    s_add_u32 s52, s52, 14336
    s_cmp_ge_u32 s52, 200704
    s_cselect_b32 s52, 0, s52
    s_add_u32 m0, s77, 51200
    s_add_u32 s57, s52, 0
    buffer_load_dwordx4 v19, s[12:15], s57 offen lds
    s_add_u32 m0, s77, 52224
    s_add_u32 s57, s52, 7168
    buffer_load_dwordx4 v19, s[12:15], s57 offen lds
    s_add_u32 m0, s77, 57344
    s_add_u32 s57, s52, 200704
    buffer_load_dwordx4 v19, s[12:15], s57 offen lds
    s_add_u32 m0, s77, 58368
    s_add_u32 s57, s52, 207872
    buffer_load_dwordx4 v19, s[12:15], s57 offen lds
    s_add_u32 s52, s52, 14336
    s_cmp_ge_u32 s52, 200704
    s_cselect_b32 s52, 0, s52
    s_add_u32 m0, s77, 53248
    s_add_u32 s57, s52, 0
    buffer_load_dwordx4 v19, s[12:15], s57 offen lds
    s_add_u32 m0, s77, 54272
    s_add_u32 s57, s52, 7168
    buffer_load_dwordx4 v19, s[12:15], s57 offen lds
    s_add_u32 m0, s77, 59392
    s_add_u32 s57, s52, 200704
    buffer_load_dwordx4 v19, s[12:15], s57 offen lds
    s_add_u32 m0, s77, 60416
    s_add_u32 s57, s52, 207872
    buffer_load_dwordx4 v19, s[12:15], s57 offen lds
    s_add_u32 s52, s52, 14336
    s_cmp_ge_u32 s52, 200704
    s_cselect_b32 s52, 0, s52
    s_waitcnt vmcnt(28)
    ds_read_b64_tr_b16 v[176:177], v20 offset:17920
    ds_read_b64_tr_b16 v[178:179], v20 offset:18944
    ds_read_b64_tr_b16 v[180:181], v21 offset:17920
    ds_read_b64_tr_b16 v[182:183], v21 offset:18944
    s_waitcnt vmcnt(26)
    ds_read_b64_tr_b16 v[184:185], v25 offset:0
    ds_read_b64_tr_b16 v[186:187], v25 offset:1024
    ds_read_b64_tr_b16 v[188:189], v26 offset:0
    ds_read_b64_tr_b16 v[190:191], v26 offset:1024
    s_waitcnt vmcnt(12)
    ds_read_b64_tr_b16 v[192:193], v25 offset:8192
    ds_read_b64_tr_b16 v[194:195], v25 offset:9216
    ds_read_b64_tr_b16 v[196:197], v26 offset:8192
    ds_read_b64_tr_b16 v[198:199], v26 offset:9216
    s_waitcnt lgkmcnt(0)
    s_lshl_b32 s57, s50, 2
    s_add_u32 s57, s57, 163696
    v_mov_b32 v2, s57
    v_mov_b32 v3, 2
    s_mov_b64 exec, 1
    ds_write_b32 v2, v3
    s_mov_b64 exec, -1
    s_waitcnt vmcnt(0)
    s_waitcnt lgkmcnt(0)
    s_lshl_b32 s57, s50, 2
    s_add_u32 s57, s57, 163696
    v_mov_b32 v2, s57
    v_mov_b32 v3, 3
    s_mov_b64 exec, 1
    ds_write_b32 v2, v3
    s_mov_b64 exec, -1
    s_branch L_ROLE_H
L_ROLE_A:
    s_setprio 1
    s_waitcnt lgkmcnt(0)
    s_mov_b32 s32, s66
    s_and_b32 s33, s67, 0xffff
    s_mov_b32 s34, 1835008
    s_mov_b32 s35, 0x20000
    s_mov_b32 s36, s68
    s_and_b32 s37, s69, 0xffff
    s_mov_b32 s38, 1835008
    s_mov_b32 s39, 0x20000
    s_sub_u32 s51, s44, 4
    s_lshl_b32 s66, s51, 11
    s_lshl_b32 s57, s60, 2
    s_load_dword s61, s[74:75], s57
    s_mov_b32 s4, s64
    s_and_b32 s5, s65, 0xffff
    s_mov_b32 s6, 1835008
    s_mov_b32 s7, 0x20000
    s_mov_b32 s12, s82
    s_and_b32 s13, s83, 0xffff
    s_mov_b32 s14, 1605632
    s_mov_b32 s15, 0x20000
    s_mov_b32 s16, s88
    s_and_b32 s17, s89, 0xffff
    s_mov_b32 s18, 25165824
    s_mov_b32 s19, 0x20000
    s_mov_b32 s20, s84
    s_and_b32 s21, s85, 0xffff
    s_mov_b32 s22, 1835008
    s_mov_b32 s23, 0x20000
    s_mov_b32 s24, s86
    s_and_b32 s25, s87, 0xffff
    s_mov_b32 s26, 256
    s_mov_b32 s27, 0x20000
    s_mov_b32 s28, s72
    s_and_b32 s29, s73, 0xffff
    s_mov_b32 s30, 1835008
    s_mov_b32 s31, 0x20000
    s_mov_b32 s40, s70
    s_and_b32 s41, s71, 0xffff
    s_mov_b32 s42, 3584
    s_mov_b32 s43, 0x20000
    s_mov_b32 s73, s59
    s_mov_b32 s70, s60
    s_bfe_u32 s53, s44, 0x10001
    v_lshlrev_b32 v22, 4, v1
    v_lshlrev_b32 v31, 6, v1
    v_lshlrev_b32 v29, 2, v1
    v_lshrrev_b32 v2, 3, v1
    v_bfe_u32 v4, v1, 4, 1
    v_and_b32 v5, 7, v1
    v_lshlrev_b32 v4, 2, v4
    v_xor_b32 v5, v5, v4
    v_mul_u32_u24 v2, 896, v2
    v_lshl_add_u32 v2, v5, 4, v2
    s_lshl_b32 s57, s48, 7
    v_add_u32 v9, s57, v2
    s_mul_i32 s57, s44, 200704
    v_add_u32 v24, s57, v9
    s_mul_i32 s76, s50, 8704
    s_add_u32 s76, s76, 122880
    s_lshl_b32 s57, s47, 1
    s_add_u32 s57, s57, s50
    s_mul_i32 s57, s57, 28672
    v_add_u32 v10, s57, v9
    v_subrev_u32 v11, 3584, v10
    v_lshlrev_b32 v2, 3, v1
    s_lshl_b32 s57, s48, 9
    buffer_load_dwordx2 v[98:99], v2, s[40:43], s57 offen
    s_mov_b32 m0, s76
    s_mov_b32 exec_hi, 0
    buffer_load_dwordx4 v11, s[32:35], 0 offen lds
    s_mov_b64 exec, -1
    s_add_u32 m0, s76, 512
    s_mov_b32 s57, 0
    buffer_load_dwordx4 v10, s[32:35], s57 offen lds
    s_add_u32 m0, s76, 4608
    s_nop 0
    buffer_load_dwordx4 v10, s[36:39], s57 offen lds
    s_add_u32 m0, s76, 1536
    s_mov_b32 s57, 7168
    buffer_load_dwordx4 v10, s[32:35], s57 offen lds
    s_add_u32 m0, s76, 5632
    s_nop 0
    buffer_load_dwordx4 v10, s[36:39], s57 offen lds
    s_add_u32 m0, s76, 2560
    s_mov_b32 s57, 14336
    buffer_load_dwordx4 v10, s[32:35], s57 offen lds
    s_add_u32 m0, s76, 6656
    s_nop 0
    buffer_load_dwordx4 v10, s[36:39], s57 offen lds
    s_add_u32 m0, s76, 3584
    s_mov_b32 s57, 21504
    buffer_load_dwordx4 v10, s[32:35], s57 offen lds
    s_add_u32 m0, s76, 7680
    s_nop 0
    buffer_load_dwordx4 v10, s[36:39], s57 offen lds
    s_add_u32 s59, s76, 4608
    v_add_u32 v14, s59, v22
    v_lshrrev_b32 v3, 5, v1
    v_bfe_u32 v2, v1, 4, 1
    v_bfe_u32 v4, v1, 2, 2
    v_and_b32 v5, 3, v1
    v_lshrrev_b32 v6, 1, v4
    v_lshlrev_b32 v7, 5, v2
    v_lshl_add_u32 v7, v5, 3, v7
    v_lshl_add_u32 v7, v4, 7, v7
    v_lshl_add_u32 v8, v6, 6, v7
    v_lshl_add_u32 v8, v3, 9, v8
    v_add_u32 v25, s66, v8
    v_xor_b32 v26, 64, v25
    s_mul_i32 s68, s47, 224
    s_mul_i32 s57, s44, 14
    s_add_u32 s68, s68, s57
    s_lshl_b32 s68, s68, 10
    s_add_u32 s68, s68, 4194304
    s_add_u32 s69, s68, 114688
    s_lshl_b32 s57, s48, 1
    s_lshl_b32 s58, s73, 2
    s_add_u32 s57, s57, s58
    s_sub_u32 s58, s57, 14
    s_cmp_ge_u32 s57, 14
    s_cselect_b32 s57, s58, s57
    s_mul_i32 s71, s57, 14336
    s_lshl_b32 s72, s57, 10
    s_waitcnt lgkmcnt(0)
    s_lshl_b32 s57, s61, 16
    s_and_b32 s58, s61, 0xffff0000
    s_cmp_eq_u32 s53, 0
    s_cselect_b32 s61, s57, s58
    v_add_u32 v20, 131072, v25
    v_add_u32 v21, 131072, v26
    v_xor_b32 v6, v6, v3
    v_lshl_add_u32 v8, v6, 6, v7
    v_add_u32 v19, s76, v8
    s_barrier
    s_waitcnt vmcnt(6)
    v_lshlrev_b32 v100, 16, v98
    v_and_b32 v101, 0xffff0000, v98
    v_lshlrev_b32 v102, 16, v99
    v_and_b32 v103, 0xffff0000, v99
    ds_read_b64_tr_b16 v[64:65], v19 offset:0
    ds_read_b64_tr_b16 v[66:67], v19 offset:512
    ds_read_b64_tr_b16 v[68:69], v19 offset:1024
    ds_read_b64_tr_b16 v[70:71], v19 offset:4608
    ds_read_b64_tr_b16 v[72:73], v19 offset:5120
    s_waitcnt lgkmcnt(2)
    v_and_b32 v74, 0xffff0000, v64
    v_lshlrev_b32 v75, 16, v65
    v_and_b32 v76, 0xffff0000, v65
    v_lshlrev_b32 v77, 16, v66
    v_and_b32 v78, 0xffff0000, v66
    v_lshlrev_b32 v79, 16, v67
    v_and_b32 v80, 0xffff0000, v67
    v_lshlrev_b32 v81, 16, v68
    v_and_b32 v82, 0xffff0000, v68
    v_lshlrev_b32 v83, 16, v69
    v_and_b32 v84, 0xffff0000, v69
    v_mul_f32 v86, v74, v103
    v_mul_f32 v87, v75, v103
    v_mul_f32 v88, v76, v103
    v_mul_f32 v89, v77, v103
    v_mul_f32 v90, v78, v103
    v_mul_f32 v91, v79, v103
    v_mul_f32 v92, v80, v103
    v_mul_f32 v93, v81, v103
    v_fmac_f32 v86, v75, v102
    v_fmac_f32 v87, v76, v102
    v_fmac_f32 v88, v77, v102
    v_fmac_f32 v89, v78, v102
    v_fmac_f32 v90, v79, v102
    v_fmac_f32 v91, v80, v102
    v_fmac_f32 v92, v81, v102
    v_fmac_f32 v93, v82, v102
    v_fmac_f32 v86, v76, v101
    v_fmac_f32 v87, v77, v101
    v_fmac_f32 v88, v78, v101
    v_fmac_f32 v89, v79, v101
    v_fmac_f32 v90, v80, v101
    v_fmac_f32 v91, v81, v101
    v_fmac_f32 v92, v82, v101
    v_fmac_f32 v93, v83, v101
    v_fmac_f32 v86, v77, v100
    v_fmac_f32 v87, v78, v100
    v_fmac_f32 v88, v79, v100
    v_fmac_f32 v89, v80, v100
    v_fmac_f32 v90, v81, v100
    v_fmac_f32 v91, v82, v100
    v_fmac_f32 v92, v83, v100
    v_fmac_f32 v93, v84, v100
    s_waitcnt lgkmcnt(0)
    v_lshlrev_b32 v74, 16, v70
    v_and_b32 v75, 0xffff0000, v70
    v_lshlrev_b32 v76, 16, v71
    v_and_b32 v77, 0xffff0000, v71
    v_lshlrev_b32 v78, 16, v72
    v_and_b32 v79, 0xffff0000, v72
    v_lshlrev_b32 v80, 16, v73
    v_and_b32 v81, 0xffff0000, v73
    v_mul_f32 v86, v86, v74
    v_mul_f32 v87, v87, v75
    v_mul_f32 v88, v88, v76
    v_mul_f32 v89, v89, v77
    v_mul_f32 v90, v90, v78
    v_mul_f32 v91, v91, v79
    v_mul_f32 v92, v92, v80
    v_mul_f32 v93, v93, v81
    v_cvt_pk_bf16_f32 v104, v93, v92
    v_cvt_pk_bf16_f32 v105, v91, v90
    v_cvt_pk_bf16_f32 v106, v89, v88
    v_cvt_pk_bf16_f32 v107, v87, v86
    ds_write_b128 v14, v[104:107] offset:0
    s_waitcnt vmcnt(4)
    ds_read_b64_tr_b16 v[64:65], v19 offset:1024
    ds_read_b64_tr_b16 v[66:67], v19 offset:1536
    ds_read_b64_tr_b16 v[68:69], v19 offset:2048
    ds_read_b64_tr_b16 v[70:71], v19 offset:5632
    ds_read_b64_tr_b16 v[72:73], v19 offset:6144
    s_waitcnt lgkmcnt(2)
    v_and_b32 v74, 0xffff0000, v64
    v_lshlrev_b32 v75, 16, v65
    v_and_b32 v76, 0xffff0000, v65
    v_lshlrev_b32 v77, 16, v66
    v_and_b32 v78, 0xffff0000, v66
    v_lshlrev_b32 v79, 16, v67
    v_and_b32 v80, 0xffff0000, v67
    v_lshlrev_b32 v81, 16, v68
    v_and_b32 v82, 0xffff0000, v68
    v_lshlrev_b32 v83, 16, v69
    v_and_b32 v84, 0xffff0000, v69
    v_mul_f32 v86, v74, v103
    v_mul_f32 v87, v75, v103
    v_mul_f32 v88, v76, v103
    v_mul_f32 v89, v77, v103
    v_mul_f32 v90, v78, v103
    v_mul_f32 v91, v79, v103
    v_mul_f32 v92, v80, v103
    v_mul_f32 v93, v81, v103
    v_fmac_f32 v86, v75, v102
    v_fmac_f32 v87, v76, v102
    v_fmac_f32 v88, v77, v102
    v_fmac_f32 v89, v78, v102
    v_fmac_f32 v90, v79, v102
    v_fmac_f32 v91, v80, v102
    v_fmac_f32 v92, v81, v102
    v_fmac_f32 v93, v82, v102
    v_fmac_f32 v86, v76, v101
    v_fmac_f32 v87, v77, v101
    v_fmac_f32 v88, v78, v101
    v_fmac_f32 v89, v79, v101
    v_fmac_f32 v90, v80, v101
    v_fmac_f32 v91, v81, v101
    v_fmac_f32 v92, v82, v101
    v_fmac_f32 v93, v83, v101
    v_fmac_f32 v86, v77, v100
    v_fmac_f32 v87, v78, v100
    v_fmac_f32 v88, v79, v100
    v_fmac_f32 v89, v80, v100
    v_fmac_f32 v90, v81, v100
    v_fmac_f32 v91, v82, v100
    v_fmac_f32 v92, v83, v100
    v_fmac_f32 v93, v84, v100
    s_waitcnt lgkmcnt(0)
    v_lshlrev_b32 v74, 16, v70
    v_and_b32 v75, 0xffff0000, v70
    v_lshlrev_b32 v76, 16, v71
    v_and_b32 v77, 0xffff0000, v71
    v_lshlrev_b32 v78, 16, v72
    v_and_b32 v79, 0xffff0000, v72
    v_lshlrev_b32 v80, 16, v73
    v_and_b32 v81, 0xffff0000, v73
    v_mul_f32 v86, v86, v74
    v_mul_f32 v87, v87, v75
    v_mul_f32 v88, v88, v76
    v_mul_f32 v89, v89, v77
    v_mul_f32 v90, v90, v78
    v_mul_f32 v91, v91, v79
    v_mul_f32 v92, v92, v80
    v_mul_f32 v93, v93, v81
    v_cvt_pk_bf16_f32 v104, v93, v92
    v_cvt_pk_bf16_f32 v105, v91, v90
    v_cvt_pk_bf16_f32 v106, v89, v88
    v_cvt_pk_bf16_f32 v107, v87, v86
    ds_write_b128 v14, v[104:107] offset:1024
    s_barrier
    s_waitcnt vmcnt(2)
    ds_read_b64_tr_b16 v[64:65], v19 offset:2048
    ds_read_b64_tr_b16 v[66:67], v19 offset:2560
    ds_read_b64_tr_b16 v[68:69], v19 offset:3072
    ds_read_b64_tr_b16 v[70:71], v19 offset:6656
    ds_read_b64_tr_b16 v[72:73], v19 offset:7168
    s_waitcnt lgkmcnt(2)
    v_and_b32 v74, 0xffff0000, v64
    v_lshlrev_b32 v75, 16, v65
    v_and_b32 v76, 0xffff0000, v65
    v_lshlrev_b32 v77, 16, v66
    v_and_b32 v78, 0xffff0000, v66
    v_lshlrev_b32 v79, 16, v67
    v_and_b32 v80, 0xffff0000, v67
    v_lshlrev_b32 v81, 16, v68
    v_and_b32 v82, 0xffff0000, v68
    v_lshlrev_b32 v83, 16, v69
    v_and_b32 v84, 0xffff0000, v69
    v_mul_f32 v86, v74, v103
    v_mul_f32 v87, v75, v103
    v_mul_f32 v88, v76, v103
    v_mul_f32 v89, v77, v103
    v_mul_f32 v90, v78, v103
    v_mul_f32 v91, v79, v103
    v_mul_f32 v92, v80, v103
    v_mul_f32 v93, v81, v103
    v_fmac_f32 v86, v75, v102
    v_fmac_f32 v87, v76, v102
    v_fmac_f32 v88, v77, v102
    v_fmac_f32 v89, v78, v102
    v_fmac_f32 v90, v79, v102
    v_fmac_f32 v91, v80, v102
    v_fmac_f32 v92, v81, v102
    v_fmac_f32 v93, v82, v102
    v_fmac_f32 v86, v76, v101
    v_fmac_f32 v87, v77, v101
    v_fmac_f32 v88, v78, v101
    v_fmac_f32 v89, v79, v101
    v_fmac_f32 v90, v80, v101
    v_fmac_f32 v91, v81, v101
    v_fmac_f32 v92, v82, v101
    v_fmac_f32 v93, v83, v101
    v_fmac_f32 v86, v77, v100
    v_fmac_f32 v87, v78, v100
    v_fmac_f32 v88, v79, v100
    v_fmac_f32 v89, v80, v100
    v_fmac_f32 v90, v81, v100
    v_fmac_f32 v91, v82, v100
    v_fmac_f32 v92, v83, v100
    v_fmac_f32 v93, v84, v100
    s_waitcnt lgkmcnt(0)
    v_lshlrev_b32 v74, 16, v70
    v_and_b32 v75, 0xffff0000, v70
    v_lshlrev_b32 v76, 16, v71
    v_and_b32 v77, 0xffff0000, v71
    v_lshlrev_b32 v78, 16, v72
    v_and_b32 v79, 0xffff0000, v72
    v_lshlrev_b32 v80, 16, v73
    v_and_b32 v81, 0xffff0000, v73
    v_mul_f32 v86, v86, v74
    v_mul_f32 v87, v87, v75
    v_mul_f32 v88, v88, v76
    v_mul_f32 v89, v89, v77
    v_mul_f32 v90, v90, v78
    v_mul_f32 v91, v91, v79
    v_mul_f32 v92, v92, v80
    v_mul_f32 v93, v93, v81
    v_cvt_pk_bf16_f32 v104, v93, v92
    v_cvt_pk_bf16_f32 v105, v91, v90
    v_cvt_pk_bf16_f32 v106, v89, v88
    v_cvt_pk_bf16_f32 v107, v87, v86
    ds_write_b128 v14, v[104:107] offset:2048
    s_waitcnt vmcnt(0)
    ds_read_b64_tr_b16 v[64:65], v19 offset:3072
    ds_read_b64_tr_b16 v[66:67], v19 offset:3584
    ds_read_b64_tr_b16 v[68:69], v19 offset:4096
    ds_read_b64_tr_b16 v[70:71], v19 offset:7680
    ds_read_b64_tr_b16 v[72:73], v19 offset:8192
    s_waitcnt lgkmcnt(2)
    v_and_b32 v74, 0xffff0000, v64
    v_lshlrev_b32 v75, 16, v65
    v_and_b32 v76, 0xffff0000, v65
    v_lshlrev_b32 v77, 16, v66
    v_and_b32 v78, 0xffff0000, v66
    v_lshlrev_b32 v79, 16, v67
    v_and_b32 v80, 0xffff0000, v67
    v_lshlrev_b32 v81, 16, v68
    v_and_b32 v82, 0xffff0000, v68
    v_lshlrev_b32 v83, 16, v69
    v_and_b32 v84, 0xffff0000, v69
    v_mul_f32 v86, v74, v103
    v_mul_f32 v87, v75, v103
    v_mul_f32 v88, v76, v103
    v_mul_f32 v89, v77, v103
    v_mul_f32 v90, v78, v103
    v_mul_f32 v91, v79, v103
    v_mul_f32 v92, v80, v103
    v_mul_f32 v93, v81, v103
    v_fmac_f32 v86, v75, v102
    v_fmac_f32 v87, v76, v102
    v_fmac_f32 v88, v77, v102
    v_fmac_f32 v89, v78, v102
    v_fmac_f32 v90, v79, v102
    v_fmac_f32 v91, v80, v102
    v_fmac_f32 v92, v81, v102
    v_fmac_f32 v93, v82, v102
    v_fmac_f32 v86, v76, v101
    v_fmac_f32 v87, v77, v101
    v_fmac_f32 v88, v78, v101
    v_fmac_f32 v89, v79, v101
    v_fmac_f32 v90, v80, v101
    v_fmac_f32 v91, v81, v101
    v_fmac_f32 v92, v82, v101
    v_fmac_f32 v93, v83, v101
    v_fmac_f32 v86, v77, v100
    v_fmac_f32 v87, v78, v100
    v_fmac_f32 v88, v79, v100
    v_fmac_f32 v89, v80, v100
    v_fmac_f32 v90, v81, v100
    v_fmac_f32 v91, v82, v100
    v_fmac_f32 v92, v83, v100
    v_fmac_f32 v93, v84, v100
    s_waitcnt lgkmcnt(0)
    v_lshlrev_b32 v74, 16, v70
    v_and_b32 v75, 0xffff0000, v70
    v_lshlrev_b32 v76, 16, v71
    v_and_b32 v77, 0xffff0000, v71
    v_lshlrev_b32 v78, 16, v72
    v_and_b32 v79, 0xffff0000, v72
    v_lshlrev_b32 v80, 16, v73
    v_and_b32 v81, 0xffff0000, v73
    v_mul_f32 v86, v86, v74
    v_mul_f32 v87, v87, v75
    v_mul_f32 v88, v88, v76
    v_mul_f32 v89, v89, v77
    v_mul_f32 v90, v90, v78
    v_mul_f32 v91, v91, v79
    v_mul_f32 v92, v92, v80
    v_mul_f32 v93, v93, v81
    v_cvt_pk_bf16_f32 v104, v93, v92
    v_cvt_pk_bf16_f32 v105, v91, v90
    v_cvt_pk_bf16_f32 v106, v89, v88
    v_cvt_pk_bf16_f32 v107, v87, v86
    ds_write_b128 v14, v[104:107] offset:3072
    s_barrier
    s_waitcnt lgkmcnt(0)
    v_lshrrev_b32 v2, 2, v1
    v_and_b32 v3, 3, v1
    v_xor_b32 v4, 3, v3
    v_lshlrev_b32 v4, 10, v4
    v_lshl_add_u32 v4, v2, 4, v4
    v_add_u32 v4, s59, v4
    ds_read_b128 v[64:67], v4 offset:0
    ds_read_b128 v[68:71], v4 offset:256
    ds_read_b128 v[72:75], v4 offset:512
    ds_read_b128 v[76:79], v4 offset:768
    v_lshlrev_b32 v5, 12, v2
    v_lshl_add_u32 v5, v3, 4, v5
    s_lshl_b32 s57, s48, 18
    s_lshl_b32 s58, s47, 7
    s_sub_u32 s57, s57, s58
    s_lshl_b32 s58, s50, 6
    s_sub_u32 s57, s57, s58
    s_add_u32 s57, s57, 4032
    s_waitcnt lgkmcnt(3)
    buffer_store_dwordx4 v[64:67], v5, s[16:19], s57 offen sc1
    s_add_u32 s57, s57, 65536
    s_waitcnt lgkmcnt(2)
    buffer_store_dwordx4 v[68:71], v5, s[16:19], s57 offen sc1
    s_add_u32 s57, s57, 65536
    s_waitcnt lgkmcnt(1)
    buffer_store_dwordx4 v[72:75], v5, s[16:19], s57 offen sc1
    s_add_u32 s57, s57, 65536
    s_waitcnt lgkmcnt(0)
    buffer_store_dwordx4 v[76:79], v5, s[16:19], s57 offen sc1
    v_mov_b32 v12, 0
    buffer_load_dwordx2 v[12:13], v12, s[24:27], 0 offen sc1
    s_barrier
    s_barrier
    s_waitcnt vmcnt(0)
    v_readfirstlane_b32 s78, v12
    v_readfirstlane_b32 s79, v13
    s_nop 3
    s_cmp_lg_u32 s79, 0
    s_cbranch_scc1 L_OK_7
    s_mov_b32 s67, 0
L_SPIN_8:
    s_sleep 1
    v_mov_b32 v12, 0
    buffer_load_dwordx2 v[12:13], v12, s[24:27], 0 offen sc1
    s_waitcnt vmcnt(0)
    v_readfirstlane_b32 s78, v12
    v_readfirstlane_b32 s79, v13
    s_nop 3
    s_cmp_lg_u32 s79, 0
    s_cbranch_scc1 L_OK_7
    s_add_u32 s67, s67, 1
    s_cmp_lt_u32 s67, 200000
    s_cbranch_scc1 L_SPIN_8
L_OK_7:
    s_lshl_b32 s57, s48, 5
    s_add_u32 s57, s57, s47
    s_lshl_b32 s57, s57, 6
    s_lshl_b32 s58, s50, 3
    s_add_u32 s57, s57, s58
    s_add_u32 s57, s57, 14155776
    v_mov_b32 v3, 0
    v_mov_b32 v2, 163760
    s_mov_b64 exec, 1
    buffer_store_dwordx2 v[12:13], v3, s[16:19], s57 offen sc1
    ds_write_b64 v2, v[12:13]
    s_mov_b64 exec, -1
    s_waitcnt lgkmcnt(0)
    s_barrier
    s_barrier
    s_barrier
    s_barrier
    s_barrier
    s_mov_b32 s60, 14170112
    s_mov_b32 exec_hi, 0
    buffer_load_dwordx4 v[104:107], v31, s[16:19], s60 offen sc1
    s_mov_b64 exec, -1
    s_barrier
    s_barrier
    s_add_u32 m0, s66, 140800
    s_add_u32 s57, s71, 7168
    buffer_load_dwordx4 v24, s[12:15], s71 offen lds
    s_add_u32 m0, s66, 141824
    s_add_u32 s71, s71, 14336
    buffer_load_dwordx4 v24, s[12:15], s57 offen lds
    s_cmp_ge_u32 s71, 200704
    s_cselect_b32 s71, 0, s71
    s_waitcnt vmcnt(2)
    v_cmp_eq_u64 vcc, s[78:79], v[104:105]
    v_cmp_eq_u64 s[62:63], s[78:79], v[106:107]
    s_nop 3
    s_and_b32 s57, vcc_lo, s62
    s_and_b32 s57, s57, -1
    s_cmp_eq_u32 s57, -1
    s_cbranch_scc1 L_OK_9
    s_mov_b32 s67, 0
L_SPIN_10:
    s_sleep 1
    s_mov_b32 exec_hi, 0
    buffer_load_dwordx4 v[104:107], v31, s[16:19], s60 offen sc1
    s_mov_b64 exec, -1
    s_waitcnt vmcnt(0)
    v_cmp_eq_u64 vcc, s[78:79], v[104:105]
    v_cmp_eq_u64 s[62:63], s[78:79], v[106:107]
    s_nop 3
    s_and_b32 s57, vcc_lo, s62
    s_and_b32 s57, s57, -1
    s_cmp_eq_u32 s57, -1
    s_cbranch_scc1 L_OK_9
    s_add_u32 s67, s67, 1
    s_cmp_lt_u32 s67, 200000
    s_cbranch_scc1 L_SPIN_10
L_OK_9:
    s_lshl_b32 s57, s45, 11
    s_add_u32 s57, s57, 12582912
    s_add_u32 s58, s57, 1024
    s_lshl_b32 s77, s46, 10
    s_add_u32 s77, s77, 12648448
    s_add_u32 s60, s77, 14336
    s_cmp_eq_u32 s50, 0
    s_cselect_b32 s57, s57, s77
    s_cselect_b32 s58, s58, s60
    buffer_load_dwordx4 v[96:99], v22, s[16:19], s57 offen sc1
    buffer_load_dwordx4 v[100:103], v22, s[16:19], s58 offen sc1
    s_lshr_b32 s60, s70, 5
    s_lshl_b32 s60, s60, 11
    s_add_u32 s60, s60, 14155776
    s_mov_b32 exec_hi, 0
    buffer_load_dwordx4 v[104:107], v31, s[16:19], s60 offen sc1
    s_mov_b64 exec, -1
    s_lshl_b32 s59, s70, 1
    s_add_u32 s59, s59, s50
    s_lshl_b32 s59, s59, 12
    buffer_load_dwordx4 v[192:195], v22, s[28:31], s59 offen offset:0
    buffer_load_dwordx2 v[196:197], v22, s[28:31], s59 offen offset:16
    buffer_load_dwordx4 v[198:201], v22, s[28:31], s59 offen offset:1024
    buffer_load_dwordx2 v[202:203], v22, s[28:31], s59 offen offset:1040
    buffer_load_dwordx4 v[204:207], v22, s[28:31], s59 offen offset:2048
    buffer_load_dwordx2 v[208:209], v22, s[28:31], s59 offen offset:2064
    buffer_load_dwordx4 v[210:213], v22, s[28:31], s59 offen offset:3072
    buffer_load_dwordx2 v[214:215], v22, s[28:31], s59 offen offset:3088
    s_barrier
    s_add_u32 m0, s66, 148992
    s_add_u32 s57, s71, 7168
    buffer_load_dwordx4 v24, s[12:15], s71 offen lds
    s_add_u32 m0, s66, 150016
    s_add_u32 s71, s71, 14336
    buffer_load_dwordx4 v24, s[12:15], s57 offen lds
    s_cmp_ge_u32 s71, 200704
    s_cselect_b32 s71, 0, s71
    s_add_u32 m0, s66, 0
    s_add_u32 s57, s71, 7168
    buffer_load_dwordx4 v24, s[12:15], s71 offen lds
    s_add_u32 m0, s66, 1024
    s_add_u32 s71, s71, 14336
    buffer_load_dwordx4 v24, s[12:15], s57 offen lds
    s_cmp_ge_u32 s71, 200704
    s_cselect_b32 s71, 0, s71
    s_add_u32 m0, s66, 8192
    s_add_u32 s57, s71, 7168
    buffer_load_dwordx4 v24, s[12:15], s71 offen lds
    s_add_u32 m0, s66, 9216
    s_add_u32 s71, s71, 14336
    buffer_load_dwordx4 v24, s[12:15], s57 offen lds
    s_cmp_ge_u32 s71, 200704
    s_cselect_b32 s71, 0, s71
    s_add_u32 m0, s66, 16384
    s_add_u32 s57, s71, 7168
    buffer_load_dwordx4 v24, s[12:15], s71 offen lds
    s_add_u32 m0, s66, 17408
    s_add_u32 s71, s71, 14336
    buffer_load_dwordx4 v24, s[12:15], s57 offen lds
    s_cmp_ge_u32 s71, 200704
    s_cselect_b32 s71, 0, s71
    s_lshl_b32 s57, s50, 11
    s_add_u32 s57, s57, 157184
    v_add_u32 v4, s57, v22
    s_waitcnt vmcnt(17)
    ds_write_b128 v4, v[96:99]
    ds_write_b128 v4, v[100:103] offset:1024
    s_waitcnt lgkmcnt(0)
    s_lshl_b32 s57, s50, 2
    s_add_u32 s57, s57, 163616
    v_mov_b32 v2, s57
    v_mov_b32 v3, 1
    s_mov_b64 exec, 1
    ds_write_b32 v2, v3
    s_mov_b64 exec, -1
    s_mul_i32 s57, s50, 16640
    s_add_u32 s57, s57, 98304
    v_add_u32 v14, s57, v22
    s_waitcnt vmcnt(16)
    v_cmp_eq_u64 vcc, s[78:79], v[104:105]
    v_cmp_eq_u64 s[62:63], s[78:79], v[106:107]
    s_nop 3
    s_and_b32 s57, vcc_lo, s62
    s_and_b32 s57, s57, -1
    s_cmp_eq_u32 s57, -1
    s_cbranch_scc1 L_OK_11
    s_mov_b32 s67, 0
L_SPIN_12:
    s_sleep 1
    s_mov_b32 exec_hi, 0
    buffer_load_dwordx4 v[104:107], v31, s[16:19], s60 offen sc1
    s_mov_b64 exec, -1
    s_waitcnt vmcnt(0)
    v_cmp_eq_u64 vcc, s[78:79], v[104:105]
    v_cmp_eq_u64 s[62:63], s[78:79], v[106:107]
    s_nop 3
    s_and_b32 s57, vcc_lo, s62
    s_and_b32 s57, s57, -1
    s_cmp_eq_u32 s57, -1
    s_cbranch_scc1 L_OK_11
    s_add_u32 s67, s67, 1
    s_cmp_lt_u32 s67, 200000
    s_cbranch_scc1 L_SPIN_12
L_OK_11:
    buffer_load_dwordx4 v[64:67], v22, s[16:19], s59 offen offset:0 sc1
    buffer_load_dwordx4 v[68:71], v22, s[16:19], s59 offen offset:1024 sc1
    buffer_load_dwordx4 v[72:75], v22, s[16:19], s59 offen offset:2048 sc1
    buffer_load_dwordx4 v[76:79], v22, s[16:19], s59 offen offset:3072 sc1
    s_waitcnt vmcnt(12)
    v_alignbit_b32 v32, v193, v192, 16
    v_alignbit_b32 v33, v194, v193, 16
    v_alignbit_b32 v34, v195, v194, 16
    v_alignbit_b32 v35, v196, v195, 16
    v_alignbit_b32 v36, v197, v196, 16
    v_mov_b32 v38, v192
    v_mov_b32 v42, v193
    v_mov_b32 v46, v33
    v_mov_b32 v39, v193
    v_mov_b32 v43, v194
    v_mov_b32 v47, v34
    v_mov_b32 v40, v194
    v_mov_b32 v44, v195
    v_mov_b32 v48, v35
    v_mov_b32 v41, v195
    v_mov_b32 v45, v196
    v_mov_b32 v49, v36
    ds_write_b128 v14, v[38:41] offset:32
    ds_write_b128 v14, v[32:35] offset:4192
    ds_write_b128 v14, v[42:45] offset:8352
    ds_write_b128 v14, v[46:49] offset:12512
    s_waitcnt lgkmcnt(0)
    v_alignbit_b32 v32, v199, v198, 16
    v_alignbit_b32 v33, v200, v199, 16
    v_alignbit_b32 v34, v201, v200, 16
    v_alignbit_b32 v35, v202, v201, 16
    v_alignbit_b32 v36, v203, v202, 16
    v_mov_b32 v38, v198
    v_mov_b32 v42, v199
    v_mov_b32 v46, v33
    v_mov_b32 v39, v199
    v_mov_b32 v43, v200
    v_mov_b32 v47, v34
    v_mov_b32 v40, v200
    v_mov_b32 v44, v201
    v_mov_b32 v48, v35
    v_mov_b32 v41, v201
    v_mov_b32 v45, v202
    v_mov_b32 v49, v36
    ds_write_b128 v14, v[38:41] offset:1056
    ds_write_b128 v14, v[32:35] offset:5216
    ds_write_b128 v14, v[42:45] offset:9376
    ds_write_b128 v14, v[46:49] offset:13536
    s_waitcnt lgkmcnt(0)
    v_alignbit_b32 v32, v205, v204, 16
    v_alignbit_b32 v33, v206, v205, 16
    v_alignbit_b32 v34, v207, v206, 16
    v_alignbit_b32 v35, v208, v207, 16
    v_alignbit_b32 v36, v209, v208, 16
    v_mov_b32 v38, v204
    v_mov_b32 v42, v205
    v_mov_b32 v46, v33
    v_mov_b32 v39, v205
    v_mov_b32 v43, v206
    v_mov_b32 v47, v34
    v_mov_b32 v40, v206
    v_mov_b32 v44, v207
    v_mov_b32 v48, v35
    v_mov_b32 v41, v207
    v_mov_b32 v45, v208
    v_mov_b32 v49, v36
    ds_write_b128 v14, v[38:41] offset:2080
    ds_write_b128 v14, v[32:35] offset:6240
    ds_write_b128 v14, v[42:45] offset:10400
    ds_write_b128 v14, v[46:49] offset:14560
    s_waitcnt lgkmcnt(0)
    v_alignbit_b32 v32, v211, v210, 16
    v_alignbit_b32 v33, v212, v211, 16
    v_alignbit_b32 v34, v213, v212, 16
    v_alignbit_b32 v35, v214, v213, 16
    v_alignbit_b32 v36, v215, v214, 16
    v_mov_b32 v38, v210
    v_mov_b32 v42, v211
    v_mov_b32 v46, v33
    v_mov_b32 v39, v211
    v_mov_b32 v43, v212
    v_mov_b32 v47, v34
    v_mov_b32 v40, v212
    v_mov_b32 v44, v213
    v_mov_b32 v48, v35
    v_mov_b32 v41, v213
    v_mov_b32 v45, v214
    v_mov_b32 v49, v36
    ds_write_b128 v14, v[38:41] offset:3104
    ds_write_b128 v14, v[32:35] offset:7264
    ds_write_b128 v14, v[42:45] offset:11424
    ds_write_b128 v14, v[46:49] offset:15584
    s_waitcnt lgkmcnt(0)
    v_mov_b32 v4, 0
    v_mov_b32 v5, 0
    v_mov_b32 v6, 0
    v_mov_b32 v7, 0
    v_mov_b32 v8, 0
    v_mov_b32 v9, 0
    v_readlane_b32 s57, v192, 0
    v_readlane_b32 s58, v193, 0
    s_nop 3
    v_writelane_b32 v8, s57, 1
    v_writelane_b32 v9, s58, 1
    s_mov_b64 exec, 3
    v_alignbit_b32 v32, v4, v4, 16
    v_alignbit_b32 v33, v4, v4, 16
    v_alignbit_b32 v34, v4, v4, 16
    v_alignbit_b32 v35, v8, v4, 16
    v_alignbit_b32 v36, v9, v8, 16
    v_mov_b32 v38, v4
    v_mov_b32 v42, v4
    v_mov_b32 v46, v33
    v_mov_b32 v39, v4
    v_mov_b32 v43, v4
    v_mov_b32 v47, v34
    v_mov_b32 v40, v4
    v_mov_b32 v44, v4
    v_mov_b32 v48, v35
    v_mov_b32 v41, v4
    v_mov_b32 v45, v8
    v_mov_b32 v49, v36
    ds_write_b128 v14, v[38:41] offset:0
    ds_write_b128 v14, v[32:35] offset:4160
    ds_write_b128 v14, v[42:45] offset:8320
    ds_write_b128 v14, v[46:49] offset:12480
    s_waitcnt lgkmcnt(0)
    s_mul_i32 s57, s50, 4608
    s_add_u32 s57, s57, 131584
    s_mov_b64 exec, -1
    v_add_u32 v10, s57, v22
    s_mov_b64 exec, 0x3fffffff
    ds_write_b128 v10, v[4:7] offset:4096
    s_mov_b64 exec, -1
    ds_read_b64_tr_b16 v[128:129], v20 offset:9728
    ds_read_b64_tr_b16 v[130:131], v20 offset:10752
    ds_read_b64_tr_b16 v[132:133], v21 offset:9728
    ds_read_b64_tr_b16 v[134:135], v21 offset:10752
    s_waitcnt lgkmcnt(0)
    s_add_u32 m0, s66, 140800
    s_add_u32 s57, s71, 7168
    buffer_load_dwordx4 v24, s[12:15], s71 offen lds
    s_add_u32 m0, s66, 141824
    s_add_u32 s71, s71, 14336
    buffer_load_dwordx4 v24, s[12:15], s57 offen lds
    s_cmp_ge_u32 s71, 200704
    s_cselect_b32 s71, 0, s71
    s_waitcnt vmcnt(12)
    ds_read_b64_tr_b16 v[136:137], v20 offset:17920
    ds_read_b64_tr_b16 v[138:139], v20 offset:18944
    ds_read_b64_tr_b16 v[140:141], v21 offset:17920
    ds_read_b64_tr_b16 v[142:143], v21 offset:18944
    s_waitcnt lgkmcnt(0)
    s_add_u32 m0, s66, 148992
    s_add_u32 s57, s71, 7168
    buffer_load_dwordx4 v24, s[12:15], s71 offen lds
    s_add_u32 m0, s66, 150016
    s_add_u32 s71, s71, 14336
    buffer_load_dwordx4 v24, s[12:15], s57 offen lds
    s_cmp_ge_u32 s71, 200704
    s_cselect_b32 s71, 0, s71
    s_waitcnt vmcnt(12)
    ds_read_b64_tr_b16 v[144:145], v25 offset:0
    ds_read_b64_tr_b16 v[146:147], v25 offset:1024
    ds_read_b64_tr_b16 v[148:149], v26 offset:0
    ds_read_b64_tr_b16 v[150:151], v26 offset:1024
    s_waitcnt lgkmcnt(0)
    s_add_u32 m0, s66, 0
    s_add_u32 s57, s71, 7168
    buffer_load_dwordx4 v24, s[12:15], s71 offen lds
    s_add_u32 m0, s66, 1024
    s_add_u32 s71, s71, 14336
    buffer_load_dwordx4 v24, s[12:15], s57 offen lds
    s_cmp_ge_u32 s71, 200704
    s_cselect_b32 s71, 0, s71
    s_waitcnt vmcnt(12)
    ds_read_b64_tr_b16 v[152:153], v25 offset:8192
    ds_read_b64_tr_b16 v[154:155], v25 offset:9216
    ds_read_b64_tr_b16 v[156:157], v26 offset:8192
    ds_read_b64_tr_b16 v[158:159], v26 offset:9216
    s_waitcnt lgkmcnt(0)
    s_add_u32 m0, s66, 8192
    s_add_u32 s57, s71, 7168
    buffer_load_dwordx4 v24, s[12:15], s71 offen lds
    s_add_u32 m0, s66, 9216
    s_add_u32 s71, s71, 14336
    buffer_load_dwordx4 v24, s[12:15], s57 offen lds
    s_cmp_ge_u32 s71, 200704
    s_cselect_b32 s71, 0, s71
    s_waitcnt vmcnt(8)
    ds_write_b128 v10, v[64:67] offset:0
    ds_write_b128 v10, v[68:71] offset:1024
    ds_write_b128 v10, v[72:75] offset:2048
    ds_write_b128 v10, v[76:79] offset:3072
    s_waitcnt lgkmcnt(0)
    s_lshl_b32 s57, s50, 2
    s_add_u32 s57, s57, 163632
    v_mov_b32 v2, s57
    v_mov_b32 v3, 1
    s_mov_b64 exec, 1
    ds_write_b32 v2, v3
    s_mov_b64 exec, -1
    ds_read_b64_tr_b16 v[160:161], v25 offset:16384
    ds_read_b64_tr_b16 v[162:163], v25 offset:17408
    ds_read_b64_tr_b16 v[164:165], v26 offset:16384
    ds_read_b64_tr_b16 v[166:167], v26 offset:17408
    s_waitcnt vmcnt(6)
    ds_read_b64_tr_b16 v[168:169], v20 offset:9728
    ds_read_b64_tr_b16 v[170:171], v20 offset:10752
    ds_read_b64_tr_b16 v[172:173], v21 offset:9728
    ds_read_b64_tr_b16 v[174:175], v21 offset:10752
    s_waitcnt vmcnt(4)
    ds_read_b64_tr_b16 v[176:177], v20 offset:17920
    ds_read_b64_tr_b16 v[178:179], v20 offset:18944
    ds_read_b64_tr_b16 v[180:181], v21 offset:17920
    ds_read_b64_tr_b16 v[182:183], v21 offset:18944
    s_waitcnt vmcnt(2)
    ds_read_b64_tr_b16 v[184:185], v25 offset:0
    ds_read_b64_tr_b16 v[186:187], v25 offset:1024
    ds_read_b64_tr_b16 v[188:189], v26 offset:0
    ds_read_b64_tr_b16 v[190:191], v26 offset:1024
    s_waitcnt vmcnt(0)
    ds_read_b64_tr_b16 v[192:193], v25 offset:8192
    ds_read_b64_tr_b16 v[194:195], v25 offset:9216
    ds_read_b64_tr_b16 v[196:197], v26 offset:8192
    ds_read_b64_tr_b16 v[198:199], v26 offset:9216
L_ROLE_H:
    s_setprio 0
    s_lshr_b32 s52, s44, 2
    s_lshl_b32 s52, s52, 1
    s_add_u32 s52, s52, s50
    v_and_b32 v2, 15, v1
    v_lshrrev_b32 v3, 4, v1
    v_add_u32 v4, 1, v2
    v_and_b32 v5, 3, v4
    v_and_b32 v4, 28, v4
    v_mul_u32_u24 v5, 4160, v5
    v_lshl_add_u32 v5, v4, 1, v5
    v_lshl_add_u32 v5, v3, 4, v5
    s_mul_i32 s57, s53, 16640
    s_lshl_b32 s58, s52, 7
    s_add_u32 s57, s57, s58
    s_add_u32 s57, s57, 98304
    v_add_u32 v27, s57, v5
    s_mul_i32 s59, s53, 4608
    s_add_u32 s57, s59, s58
    s_add_u32 s57, s57, 132064
    v_lshlrev_b32 v4, 4, v3
    v_lshlrev_b32 v5, 5, v2
    v_sub_u32 v4, v4, v5
    v_add_u32 v28, s57, v4
    s_lshl_b32 s57, s53, 15
    s_lshl_b32 s58, s52, 11
    s_add_u32 s57, s57, s58
    v_add_u32 v30, s57, v22
    s_mov_b32 s58, 0x3
    v_lshlrev_b32 v2, 2, v1
    v_add_u32 v2, 163632, v2
    v_min_u32 v2, 163836, v2
    s_mov_b32 s67, 0
L_LW_13:
    ds_read_b32 v3, v2
    s_waitcnt lgkmcnt(0)
    v_cmp_le_u32 vcc, 1, v3
    s_nop 3
    s_and_b32 s57, vcc_lo, s58
    s_cmp_eq_u32 s57, s58
    s_cbranch_scc1 L_LO_14
    s_sleep 1
    s_add_u32 s67, s67, 1
    s_cmp_lt_u32 s67, 800000
    s_cbranch_scc1 L_LW_13
L_LO_14:
    s_lshl_b32 s59, 1, s51
    v_lshlrev_b32 v2, 2, v1
    v_add_u32 v2, 163680, v2
    v_min_u32 v2, 163836, v2
    s_mov_b32 s67, 0
L_LW_15:
    ds_read_b32 v3, v2
    s_waitcnt lgkmcnt(0)
    v_cmp_le_u32 vcc, 1, v3
    s_nop 3
    s_and_b32 s57, vcc_lo, s59
    s_cmp_eq_u32 s57, s59
    s_cbranch_scc1 L_LO_16
    s_sleep 1
    s_add_u32 s67, s67, 1
    s_cmp_lt_u32 s67, 800000
    s_cbranch_scc1 L_LW_15
L_LO_16:
    ds_read_b64 v[32:33], v27 offset:0
    ds_read_b64 v[34:35], v27 offset:8
    ds_read_b128 v[36:39], v28 offset:3584
    ds_read_b64 v[40:41], v27 offset:512
    ds_read_b64 v[42:43], v27 offset:520
    ds_read_b128 v[44:47], v28 offset:3072
    ds_read_b64 v[48:49], v27 offset:1024
    ds_read_b64 v[50:51], v27 offset:1032
    ds_read_b128 v[52:55], v28 offset:2560
    ds_read_b64 v[56:57], v27 offset:1536
    ds_read_b64 v[58:59], v27 offset:1544
    ds_read_b128 v[60:63], v28 offset:2048
    s_waitcnt lgkmcnt(9)
    v_mfma_f32_16x16x32_bf16 v[64:67], v[32:35], v[36:39], 0
    s_waitcnt lgkmcnt(7)
    v_mfma_f32_16x16x32_bf16 v[68:71], v[40:43], v[36:39], 0
    s_waitcnt lgkmcnt(6)
    v_mfma_f32_16x16x32_bf16 v[72:75], v[40:43], v[44:47], 0
    s_add_u32 m0, s66, 16384
    s_add_u32 s57, s71, 7168
    buffer_load_dwordx4 v24, s[12:15], s71 offen lds
    s_add_u32 m0, s66, 17408
    s_add_u32 s71, s71, 14336
    buffer_load_dwordx4 v24, s[12:15], s57 offen lds
    s_cmp_ge_u32 s71, 200704
    s_cselect_b32 s71, 0, s71
    v_mfma_f32_16x16x32_bf16 v[68:71], v[32:35], v[44:47], v[68:71]
    ds_read_b64 v[96:97], v27 offset:2048
    ds_read_b64 v[98:99], v27 offset:2056
    s_waitcnt lgkmcnt(6)
    v_mfma_f32_16x16x32_bf16 v[72:75], v[48:51], v[36:39], v[72:75]
    s_add_u32 m0, s66, 140800
    s_add_u32 s57, s71, 7168
    buffer_load_dwordx4 v24, s[12:15], s71 offen lds
    s_add_u32 m0, s66, 141824
    s_add_u32 s71, s71, 14336
    buffer_load_dwordx4 v24, s[12:15], s57 offen lds
    s_cmp_ge_u32 s71, 200704
    s_cselect_b32 s71, 0, s71
    v_mfma_f32_16x16x32_bf16 v[76:79], v[48:51], v[44:47], 0
    s_waitcnt lgkmcnt(5)
    v_mfma_f32_16x16x32_bf16 v[80:83], v[48:51], v[52:55], 0
    s_add_u32 m0, s66, 148992
    s_add_u32 s57, s71, 7168
    buffer_load_dwordx4 v24, s[12:15], s71 offen lds
    s_add_u32 m0, s66, 150016
    s_add_u32 s71, s71, 14336
    buffer_load_dwordx4 v24, s[12:15], s57 offen lds
    s_cmp_ge_u32 s71, 200704
    s_cselect_b32 s71, 0, s71
    v_mfma_f32_16x16x32_bf16 v[72:75], v[32:35], v[52:55], v[72:75]
    ds_read_b128 v[100:103], v28 offset:1536
    v_mfma_f32_16x16x32_bf16 v[76:79], v[40:43], v[52:55], v[76:79]
    s_add_u32 m0, s66, 0
    s_add_u32 s57, s71, 7168
    buffer_load_dwordx4 v24, s[12:15], s71 offen lds
    s_add_u32 m0, s66, 1024
    s_add_u32 s71, s71, 14336
    buffer_load_dwordx4 v24, s[12:15], s57 offen lds
    s_cmp_ge_u32 s71, 200704
    s_cselect_b32 s71, 0, s71
    s_waitcnt lgkmcnt(4)
    v_mfma_f32_16x16x32_bf16 v[76:79], v[56:59], v[36:39], v[76:79]
    v_mfma_f32_16x16x32_bf16 v[80:83], v[56:59], v[44:47], v[80:83]
    s_add_u32 m0, s66, 8192
    s_add_u32 s57, s71, 7168
    buffer_load_dwordx4 v24, s[12:15], s71 offen lds
    s_add_u32 m0, s66, 9216
    s_add_u32 s71, s71, 14336
    buffer_load_dwordx4 v24, s[12:15], s57 offen lds
    s_cmp_ge_u32 s71, 200704
    s_cselect_b32 s71, 0, s71
    v_mfma_f32_16x16x32_bf16 v[84:87], v[56:59], v[52:55], 0
    ds_read_b64 v[104:105], v27 offset:2560
    ds_read_b64 v[106:107], v27 offset:2568
    s_waitcnt lgkmcnt(5)
    v_mfma_f32_16x16x32_bf16 v[88:91], v[56:59], v[60:63], 0
    v_mfma_f32_16x16x32_bf16 v[76:79], v[32:35], v[60:63], v[76:79]
    v_mfma_f32_16x16x32_bf16 v[80:83], v[40:43], v[60:63], v[80:83]
    ds_read_b128 v[108:111], v28 offset:1024
    v_mfma_f32_16x16x32_bf16 v[84:87], v[48:51], v[60:63], v[84:87]
    s_waitcnt lgkmcnt(4)
    v_mfma_f32_16x16x32_bf16 v[80:83], v[96:99], v[36:39], v[80:83]
    v_mfma_f32_16x16x32_bf16 v[84:87], v[96:99], v[44:47], v[84:87]
    ds_read_b64 v[112:113], v27 offset:3072
    ds_read_b64 v[114:115], v27 offset:3080
    v_mfma_f32_16x16x32_bf16 v[88:91], v[96:99], v[52:55], v[88:91]
    v_mfma_f32_16x16x32_bf16 v[92:95], v[96:99], v[60:63], 0
    ds_read_b128 v[116:119], v28 offset:512
    s_waitcnt lgkmcnt(6)
    v_mfma_f32_16x16x32_bf16 v[80:83], v[32:35], v[100:103], v[80:83]
    v_mfma_f32_16x16x32_bf16 v[84:87], v[40:43], v[100:103], v[84:87]
    ds_read_b64 v[120:121], v27 offset:3584
    ds_read_b64 v[122:123], v27 offset:3592
    v_mfma_f32_16x16x32_bf16 v[88:91], v[48:51], v[100:103], v[88:91]
    ds_read_b128 v[124:127], v28 offset:0
    v_mfma_f32_16x16x32_bf16 v[92:95], v[56:59], v[100:103], v[92:95]
    ds_read_b64 v[240:241], v27 offset:64
    ds_read_b64 v[242:243], v27 offset:72
    ds_read_b128 v[244:247], v28 offset:3648
    s_waitcnt lgkmcnt(10)
    v_mfma_f32_16x16x32_bf16 v[84:87], v[104:107], v[36:39], v[84:87]
    ds_read_b64 v[248:249], v27 offset:576
    ds_read_b64 v[250:251], v27 offset:584
    v_mfma_f32_16x16x32_bf16 v[88:91], v[104:107], v[44:47], v[88:91]
    ds_read_b128 v[96:99], v28 offset:3136
    v_mfma_f32_16x16x32_bf16 v[92:95], v[104:107], v[52:55], v[92:95]
    s_waitcnt lgkmcnt(12)
    v_mfma_f32_16x16x32_bf16 v[84:87], v[32:35], v[108:111], v[84:87]
    ds_read_b64 v[60:61], v27 offset:1088
    ds_read_b64 v[62:63], v27 offset:1096
    v_mfma_f32_16x16x32_bf16 v[88:91], v[40:43], v[108:111], v[88:91]
    v_mfma_f32_16x16x32_bf16 v[92:95], v[48:51], v[108:111], v[92:95]
    s_waitcnt lgkmcnt(12)
    v_mfma_f32_16x16x32_bf16 v[88:91], v[112:115], v[36:39], v[88:91]
    ds_read_b128 v[56:59], v28 offset:2624
    v_mfma_f32_16x16x32_bf16 v[92:95], v[112:115], v[44:47], v[92:95]
    s_waitcnt lgkmcnt(12)
    v_mfma_f32_16x16x32_bf16 v[88:91], v[32:35], v[116:119], v[88:91]
    ds_read_b64 v[100:101], v27 offset:1600
    ds_read_b64 v[102:103], v27 offset:1608
    v_mfma_f32_16x16x32_bf16 v[92:95], v[40:43], v[116:119], v[92:95]
    s_waitcnt lgkmcnt(12)
    v_mfma_f32_16x16x32_bf16 v[92:95], v[120:123], v[36:39], v[92:95]
    s_waitcnt lgkmcnt(11)
    v_mfma_f32_16x16x32_bf16 v[92:95], v[32:35], v[124:127], v[92:95]
    ds_read_b128 v[104:107], v28 offset:2112
    s_waitcnt lgkmcnt(9)
    v_mfma_f32_16x16x32_bf16 v[64:67], v[240:243], v[244:247], v[64:67]
    s_waitcnt vmcnt(8)
    ds_read_b64_tr_b16 v[200:201], v25 offset:16384
    ds_read_b64_tr_b16 v[202:203], v25 offset:17408
    ds_read_b64_tr_b16 v[204:205], v26 offset:16384
    ds_read_b64_tr_b16 v[206:207], v26 offset:17408
    s_waitcnt lgkmcnt(11)
    v_mfma_f32_16x16x32_bf16 v[68:71], v[248:251], v[244:247], v[68:71]
    s_waitcnt lgkmcnt(10)
    v_mfma_f32_16x16x32_bf16 v[72:75], v[248:251], v[96:99], v[72:75]
    v_mfma_f32_16x16x32_bf16 v[68:71], v[240:243], v[96:99], v[68:71]
    s_waitcnt vmcnt(6)
    ds_read_b64_tr_b16 v[208:209], v20 offset:9728
    ds_read_b64_tr_b16 v[210:211], v20 offset:10752
    ds_read_b64_tr_b16 v[212:213], v21 offset:9728
    ds_read_b64_tr_b16 v[214:215], v21 offset:10752
    s_waitcnt lgkmcnt(12)
    v_mfma_f32_16x16x32_bf16 v[72:75], v[60:63], v[244:247], v[72:75]
    ds_read_b64 v[52:53], v27 offset:2112
    ds_read_b64 v[54:55], v27 offset:2120
    v_mfma_f32_16x16x32_bf16 v[76:79], v[60:63], v[96:99], v[76:79]
    s_waitcnt lgkmcnt(13)
    v_mfma_f32_16x16x32_bf16 v[80:83], v[60:63], v[56:59], v[80:83]
    v_mfma_f32_16x16x32_bf16 v[72:75], v[240:243], v[56:59], v[72:75]
    v_mfma_f32_16x16x32_bf16 v[76:79], v[248:251], v[56:59], v[76:79]
    s_waitcnt lgkmcnt(0)
    s_waitcnt vmcnt(4)
    ds_read_b64_tr_b16 v[216:217], v20 offset:17920
    ds_read_b64_tr_b16 v[218:219], v20 offset:18944
    ds_read_b64_tr_b16 v[220:221], v21 offset:17920
    ds_read_b64_tr_b16 v[222:223], v21 offset:18944
    s_waitcnt vmcnt(2)
    ds_read_b64_tr_b16 v[224:225], v25 offset:0
    ds_read_b64_tr_b16 v[226:227], v25 offset:1024
    ds_read_b64_tr_b16 v[228:229], v26 offset:0
    ds_read_b64_tr_b16 v[230:231], v26 offset:1024
    s_waitcnt vmcnt(0)
    ds_read_b64_tr_b16 v[232:233], v25 offset:8192
    ds_read_b64_tr_b16 v[234:235], v25 offset:9216
    ds_read_b64_tr_b16 v[236:237], v26 offset:8192
    ds_read_b64_tr_b16 v[238:239], v26 offset:9216
    s_waitcnt lgkmcnt(0)
    s_barrier
    ds_read_b128 v[48:51], v28 offset:1600
    v_mfma_f32_16x16x32_bf16 v[76:79], v[100:103], v[244:247], v[76:79]
    ds_write_b128 v30, v[64:67] offset:0
    v_mfma_f32_16x16x32_bf16 v[80:83], v[100:103], v[96:99], v[80:83]
    v_mfma_f32_16x16x32_bf16 v[84:87], v[100:103], v[56:59], v[84:87]
    ds_write_b128 v30, v[68:71] offset:1024
    ds_read_b64 v[108:109], v27 offset:2624
    ds_read_b64 v[110:111], v27 offset:2632
    v_mfma_f32_16x16x32_bf16 v[88:91], v[100:103], v[104:107], v[88:91]
    v_mfma_f32_16x16x32_bf16 v[76:79], v[240:243], v[104:107], v[76:79]
    v_mfma_f32_16x16x32_bf16 v[80:83], v[248:251], v[104:107], v[80:83]
    ds_read_b128 v[112:115], v28 offset:1088
    v_mfma_f32_16x16x32_bf16 v[84:87], v[60:63], v[104:107], v[84:87]
    ds_write_b128 v30, v[72:75] offset:8192
    v_mfma_f32_16x16x32_bf16 v[80:83], v[52:55], v[244:247], v[80:83]
    v_mfma_f32_16x16x32_bf16 v[84:87], v[52:55], v[96:99], v[84:87]
    ds_read_b64 v[44:45], v27 offset:3136
    ds_read_b64 v[46:47], v27 offset:3144
    v_mfma_f32_16x16x32_bf16 v[88:91], v[52:55], v[56:59], v[88:91]
    v_mfma_f32_16x16x32_bf16 v[92:95], v[52:55], v[104:107], v[92:95]
    ds_read_b128 v[40:43], v28 offset:576
    s_waitcnt lgkmcnt(9)
    v_mfma_f32_16x16x32_bf16 v[80:83], v[240:243], v[48:51], v[80:83]
    v_mfma_f32_16x16x32_bf16 v[84:87], v[248:251], v[48:51], v[84:87]
    ds_write_b128 v30, v[76:79] offset:9216
    ds_read_b64 v[116:117], v27 offset:3648
    ds_read_b64 v[118:119], v27 offset:3656
    v_mfma_f32_16x16x32_bf16 v[88:91], v[60:63], v[48:51], v[88:91]
    v_lshlrev_b32 v29, 8, v1
    s_mul_i32 s60, s47, 3584
    s_add_u32 s60, s60, 13631488
    s_mov_b64 exec, 0x3fff
    buffer_load_dwordx4 v[8:11], v29, s[16:19], s60 offen sc1
    s_mov_b64 exec, -1
    ds_read_b128 v[120:123], v28 offset:64
    v_mfma_f32_16x16x32_bf16 v[92:95], v[100:103], v[48:51], v[92:95]
    s_waitcnt lgkmcnt(9)
    v_mfma_f32_16x16x32_bf16 v[84:87], v[108:111], v[244:247], v[84:87]
    v_mfma_f32_16x16x32_bf16 v[88:91], v[108:111], v[96:99], v[88:91]
    v_mfma_f32_16x16x32_bf16 v[92:95], v[108:111], v[56:59], v[92:95]
    s_waitcnt lgkmcnt(8)
    v_mfma_f32_16x16x32_bf16 v[84:87], v[240:243], v[112:115], v[84:87]
    v_mfma_f32_16x16x32_bf16 v[88:91], v[248:251], v[112:115], v[88:91]
    ds_write_b128 v30, v[80:83] offset:16384
    v_mfma_f32_16x16x32_bf16 v[92:95], v[60:63], v[112:115], v[92:95]
    s_waitcnt lgkmcnt(6)
    v_mfma_f32_16x16x32_bf16 v[88:91], v[44:47], v[244:247], v[88:91]
    v_mfma_f32_16x16x32_bf16 v[92:95], v[44:47], v[96:99], v[92:95]
    s_waitcnt lgkmcnt(5)
    v_mfma_f32_16x16x32_bf16 v[88:91], v[240:243], v[40:43], v[88:91]
    v_mfma_f32_16x16x32_bf16 v[92:95], v[248:251], v[40:43], v[92:95]
    s_waitcnt lgkmcnt(2)
    v_mfma_f32_16x16x32_bf16 v[92:95], v[116:119], v[244:247], v[92:95]
    s_waitcnt lgkmcnt(1)
    v_mfma_f32_16x16x32_bf16 v[92:95], v[240:243], v[120:123], v[92:95]
    ds_write_b128 v30, v[84:87] offset:17408
    s_nop 7
    ds_write_b128 v30, v[88:91] offset:24576
    ds_write_b128 v30, v[92:95] offset:25600
    s_branch L_G2
L_ROLE_M:
    s_setprio 0
    s_lshr_b32 s51, s44, 1
    s_mul_i32 s57, s44, 6144
    s_add_u32 s63, s57, 24576
    s_waitcnt lgkmcnt(0)
    s_mov_b32 s66, s63
    s_lshl_b32 s57, s60, 2
    s_load_dword s61, s[74:75], s57
    s_mov_b32 s4, s64
    s_and_b32 s5, s65, 0xffff
    s_mov_b32 s6, 1835008
    s_mov_b32 s7, 0x20000
    s_mov_b32 s12, s82
    s_and_b32 s13, s83, 0xffff
    s_mov_b32 s14, 1605632
    s_mov_b32 s15, 0x20000
    s_mov_b32 s16, s88
    s_and_b32 s17, s89, 0xffff
    s_mov_b32 s18, 25165824
    s_mov_b32 s19, 0x20000
    s_mov_b32 s20, s84
    s_and_b32 s21, s85, 0xffff
    s_mov_b32 s22, 1835008
    s_mov_b32 s23, 0x20000
    s_mov_b32 s24, s86
    s_and_b32 s25, s87, 0xffff
    s_mov_b32 s26, 256
    s_mov_b32 s27, 0x20000
    s_mov_b32 s28, s72
    s_and_b32 s29, s73, 0xffff
    s_mov_b32 s30, 1835008
    s_mov_b32 s31, 0x20000
    s_mov_b32 s40, s70
    s_and_b32 s41, s71, 0xffff
    s_mov_b32 s42, 3584
    s_mov_b32 s43, 0x20000
    s_mov_b32 s73, s59
    s_mov_b32 s70, s60
    s_bfe_u32 s53, s44, 0x10001
    v_lshlrev_b32 v22, 4, v1
    v_lshlrev_b32 v31, 6, v1
    v_lshlrev_b32 v29, 2, v1
    v_lshrrev_b32 v2, 3, v1
    v_bfe_u32 v4, v1, 4, 1
    v_and_b32 v5, 7, v1
    v_lshlrev_b32 v4, 2, v4
    v_xor_b32 v5, v5, v4
    v_mul_u32_u24 v2, 896, v2
    v_lshl_add_u32 v2, v5, 4, v2
    s_lshl_b32 s57, s48, 7
    v_add_u32 v9, s57, v2
    s_mul_i32 s57, s44, 200704
    v_add_u32 v24, s57, v9
    v_lshrrev_b32 v3, 5, v1
    v_bfe_u32 v2, v1, 4, 1
    v_bfe_u32 v4, v1, 2, 2
    v_and_b32 v5, 3, v1
    v_lshrrev_b32 v6, 1, v4
    v_lshlrev_b32 v7, 5, v2
    v_lshl_add_u32 v7, v5, 3, v7
    v_lshl_add_u32 v7, v4, 7, v7
    v_lshl_add_u32 v8, v6, 6, v7
    v_lshl_add_u32 v8, v3, 9, v8
    v_add_u32 v25, s66, v8
    v_xor_b32 v26, 64, v25
    s_mul_i32 s68, s47, 224
    s_mul_i32 s57, s44, 14
    s_add_u32 s68, s68, s57
    s_lshl_b32 s68, s68, 10
    s_add_u32 s68, s68, 4194304
    s_add_u32 s69, s68, 114688
    s_lshl_b32 s57, s48, 1
    s_lshl_b32 s58, s73, 2
    s_add_u32 s57, s57, s58
    s_sub_u32 s58, s57, 14
    s_cmp_ge_u32 s57, 14
    s_cselect_b32 s57, s58, s57
    s_mul_i32 s71, s57, 14336
    s_lshl_b32 s72, s57, 10
    s_waitcnt lgkmcnt(0)
    s_lshl_b32 s57, s61, 16
    s_and_b32 s58, s61, 0xffff0000
    s_cmp_eq_u32 s53, 0
    s_cselect_b32 s61, s57, s58
    s_add_u32 s71, s71, 129024
    s_sub_u32 s57, s71, 200704
    s_cmp_ge_u32 s71, 200704
    s_cselect_b32 s71, s57, s71
    v_and_b32 v2, 31, v1
    v_lshrrev_b32 v3, 5, v1
    v_bfe_u32 v4, v1, 2, 2
    v_xor_b32 v5, v3, v4
    s_lshl_b32 s57, s50, 12
    v_lshlrev_b32 v6, 6, v2
    v_lshl_add_u32 v6, v5, 4, v6
    v_add_u32 v16, s57, v6
    v_xor_b32 v17, 32, v16
    v_bfe_u32 v2, v1, 4, 1
    v_and_b32 v5, 3, v1
    v_lshl_or_b32 v6, v2, 2, v4
    s_lshl_b32 s57, s51, 2
    v_xor_b32 v6, s57, v6
    v_lshlrev_b32 v6, 5, v6
    v_lshl_add_u32 v6, v5, 3, v6
    v_lshl_add_u32 v6, v4, 8, v6
    v_lshl_add_u32 v6, v3, 11, v6
    v_lshl_add_u32 v6, v2, 13, v6
    v_add_u32 v18, 8192, v6
    v_xor_b32 v19, 32, v18
    v_xor_b32 v20, 64, v18
    v_xor_b32 v21, 96, v18
    s_lshl_b32 s57, s45, 2
    s_lshl_b32 s58, s50, 1
    s_add_u32 s57, s57, s58
    s_lshl_b32 s59, s46, 3
    s_lshl_b32 s58, s51, 2
    s_add_u32 s59, s59, s58
    s_mul_i32 s64, s57, 112
    s_add_u32 s64, s64, s59
    s_lshl_b32 s64, s64, 10
    s_add_u32 s64, s64, 4194304
    s_add_u32 s65, s64, 114688
    v_mov_b32 v34, 0
    v_mov_b32 v35, 0
    v_mov_b32 v38, 0
    v_mov_b32 v39, 0
    v_mov_b32 v42, 0
    v_mov_b32 v43, 0
    v_mov_b32 v46, 0
    v_mov_b32 v47, 0
    v_mov_b32 v50, 0
    v_mov_b32 v51, 0
    v_mov_b32 v54, 0
    v_mov_b32 v55, 0
    v_and_b32 v2, 31, v1
    v_lshlrev_b32 v56, 4, v2
    s_lshl_b32 s57, s50, 10
    s_add_u32 s57, s57, 157184
    v_add_u32 v56, s57, v56
    v_bfe_u32 v3, v1, 4, 1
    v_and_b32 v4, 15, v1
    v_lshlrev_b32 v3, 10, v3
    v_lshl_add_u32 v57, v4, 3, v3
    s_lshl_b32 s57, s51, 9
    s_add_u32 s57, s57, 159232
    v_add_u32 v57, s57, v57
    s_lshl_b32 s57, s44, 2
    s_add_u32 s57, s57, 163600
    v_mov_b32 v60, s57
    v_mov_b32 v61, 163584
    s_barrier
    ds_read_b128 v[192:195], v16
    ds_read_b64_tr_b16 v[200:201], v18 offset:0
    ds_read_b64_tr_b16 v[202:203], v18 offset:1024
    ds_read_b128 v[196:199], v16 offset:2048
    ds_read_b64_tr_b16 v[204:205], v19 offset:0
    ds_read_b64_tr_b16 v[206:207], v19 offset:1024
    ds_read_b64_tr_b16 v[208:209], v20 offset:0
    ds_read_b64_tr_b16 v[210:211], v20 offset:1024
    ds_read_b64_tr_b16 v[212:213], v21 offset:0
    ds_read_b64_tr_b16 v[214:215], v21 offset:1024
    s_waitcnt lgkmcnt(0)
    v_mfma_f32_32x32x16_bf16 v[64:79], v[200:203], v[192:195], 0
    ds_read_b128 v[216:219], v17
    ds_read_b64_tr_b16 v[224:225], v18 offset:4096
    v_mfma_f32_32x32x16_bf16 v[80:95], v[200:203], v[196:199], 0
    ds_read_b64_tr_b16 v[226:227], v18 offset:5120
    ds_read_b128 v[220:223], v17 offset:2048
    v_mfma_f32_32x32x16_bf16 v[96:111], v[204:207], v[192:195], 0
    ds_read_b64_tr_b16 v[228:229], v19 offset:4096
    ds_read_b64_tr_b16 v[230:231], v19 offset:5120
    v_mfma_f32_32x32x16_bf16 v[112:127], v[204:207], v[196:199], 0
    ds_read_b64_tr_b16 v[232:233], v20 offset:4096
    ds_read_b64_tr_b16 v[234:235], v20 offset:5120
    v_mfma_f32_32x32x16_bf16 v[128:143], v[208:211], v[192:195], 0
    ds_read_b64_tr_b16 v[236:237], v21 offset:4096
    ds_read_b64_tr_b16 v[238:239], v21 offset:5120
    v_mfma_f32_32x32x16_bf16 v[144:159], v[208:211], v[196:199], 0
    s_barrier
    v_mfma_f32_32x32x16_bf16 v[160:175], v[212:215], v[192:195], 0
    v_mfma_f32_32x32x16_bf16 v[176:191], v[212:215], v[196:199], 0
    s_waitcnt lgkmcnt(0)
    v_mfma_f32_32x32x16_bf16 v[64:79], v[224:227], v[216:219], v[64:79]
    v_add_u32 v16, 24576, v16
    v_add_u32 v18, 24576, v18
    v_add_u32 v19, 24576, v19
    v_add_u32 v20, 24576, v20
    v_add_u32 v21, 24576, v21
    ds_read_b128 v[192:195], v16
    ds_read_b64_tr_b16 v[200:201], v18 offset:0
    v_mfma_f32_32x32x16_bf16 v[80:95], v[224:227], v[220:223], v[80:95]
    ds_read_b64_tr_b16 v[202:203], v18 offset:1024
    ds_read_b128 v[196:199], v16 offset:2048
    v_mfma_f32_32x32x16_bf16 v[96:111], v[228:231], v[216:219], v[96:111]
    ds_read_b64_tr_b16 v[204:205], v19 offset:0
    ds_read_b64_tr_b16 v[206:207], v19 offset:1024
    v_mfma_f32_32x32x16_bf16 v[112:127], v[228:231], v[220:223], v[112:127]
    ds_read_b64_tr_b16 v[208:209], v20 offset:0
    ds_read_b64_tr_b16 v[210:211], v20 offset:1024
    v_mfma_f32_32x32x16_bf16 v[128:143], v[232:235], v[216:219], v[128:143]
    ds_read_b64_tr_b16 v[212:213], v21 offset:0
    ds_read_b64_tr_b16 v[214:215], v21 offset:1024
    v_mfma_f32_32x32x16_bf16 v[144:159], v[232:235], v[220:223], v[144:159]
    v_mfma_f32_32x32x16_bf16 v[160:175], v[236:239], v[216:219], v[160:175]
    v_mfma_f32_32x32x16_bf16 v[176:191], v[236:239], v[220:223], v[176:191]
    s_waitcnt lgkmcnt(0)
    v_mfma_f32_32x32x16_bf16 v[64:79], v[200:203], v[192:195], v[64:79]
    v_add_u32 v17, 24576, v17
    ds_read_b128 v[216:219], v17
    ds_read_b64_tr_b16 v[224:225], v18 offset:4096
    v_mfma_f32_32x32x16_bf16 v[80:95], v[200:203], v[196:199], v[80:95]
    ds_read_b64_tr_b16 v[226:227], v18 offset:5120
    ds_read_b128 v[220:223], v17 offset:2048
    v_mfma_f32_32x32x16_bf16 v[96:111], v[204:207], v[192:195], v[96:111]
    ds_read_b64_tr_b16 v[228:229], v19 offset:4096
    ds_read_b64_tr_b16 v[230:231], v19 offset:5120
    v_mfma_f32_32x32x16_bf16 v[112:127], v[204:207], v[196:199], v[112:127]
    ds_read_b64_tr_b16 v[232:233], v20 offset:4096
    ds_read_b64_tr_b16 v[234:235], v20 offset:5120
    v_mfma_f32_32x32x16_bf16 v[128:143], v[208:211], v[192:195], v[128:143]
    ds_read_b64_tr_b16 v[236:237], v21 offset:4096
    ds_read_b64_tr_b16 v[238:239], v21 offset:5120
    v_mfma_f32_32x32x16_bf16 v[144:159], v[208:211], v[196:199], v[144:159]
    s_barrier
    v_mfma_f32_32x32x16_bf16 v[160:175], v[212:215], v[192:195], v[160:175]
    v_mfma_f32_32x32x16_bf16 v[176:191], v[212:215], v[196:199], v[176:191]
    s_waitcnt lgkmcnt(0)
    v_mfma_f32_32x32x16_bf16 v[64:79], v[224:227], v[216:219], v[64:79]
    v_add_u32 v16, 24576, v16
    v_add_u32 v18, 24576, v18
    v_add_u32 v19, 24576, v19
    v_add_u32 v20, 24576, v20
    v_add_u32 v21, 24576, v21
    ds_read_b128 v[192:195], v16
    ds_read_b64_tr_b16 v[200:201], v18 offset:0
    v_mfma_f32_32x32x16_bf16 v[80:95], v[224:227], v[220:223], v[80:95]
    ds_read_b64_tr_b16 v[202:203], v18 offset:1024
    ds_read_b128 v[196:199], v16 offset:2048
    v_mfma_f32_32x32x16_bf16 v[96:111], v[228:231], v[216:219], v[96:111]
    ds_read_b64_tr_b16 v[204:205], v19 offset:0
    ds_read_b64_tr_b16 v[206:207], v19 offset:1024
    v_mfma_f32_32x32x16_bf16 v[112:127], v[228:231], v[220:223], v[112:127]
    ds_read_b64_tr_b16 v[208:209], v20 offset:0
    ds_read_b64_tr_b16 v[210:211], v20 offset:1024
    v_mfma_f32_32x32x16_bf16 v[128:143], v[232:235], v[216:219], v[128:143]
    ds_read_b64_tr_b16 v[212:213], v21 offset:0
    ds_read_b64_tr_b16 v[214:215], v21 offset:1024
    v_mfma_f32_32x32x16_bf16 v[144:159], v[232:235], v[220:223], v[144:159]
    v_mfma_f32_32x32x16_bf16 v[160:175], v[236:239], v[216:219], v[160:175]
    v_mfma_f32_32x32x16_bf16 v[176:191], v[236:239], v[220:223], v[176:191]
    s_waitcnt lgkmcnt(0)
    v_mfma_f32_32x32x16_bf16 v[64:79], v[200:203], v[192:195], v[64:79]
    v_add_u32 v17, 24576, v17
    ds_read_b128 v[216:219], v17
    ds_read_b64_tr_b16 v[224:225], v18 offset:4096
    v_mfma_f32_32x32x16_bf16 v[80:95], v[200:203], v[196:199], v[80:95]
    ds_read_b64_tr_b16 v[226:227], v18 offset:5120
    ds_read_b128 v[220:223], v17 offset:2048
    v_mfma_f32_32x32x16_bf16 v[96:111], v[204:207], v[192:195], v[96:111]
    ds_read_b64_tr_b16 v[228:229], v19 offset:4096
    ds_read_b64_tr_b16 v[230:231], v19 offset:5120
    v_mfma_f32_32x32x16_bf16 v[112:127], v[204:207], v[196:199], v[112:127]
    ds_read_b64_tr_b16 v[232:233], v20 offset:4096
    ds_read_b64_tr_b16 v[234:235], v20 offset:5120
    v_mfma_f32_32x32x16_bf16 v[128:143], v[208:211], v[192:195], v[128:143]
    ds_read_b64_tr_b16 v[236:237], v21 offset:4096
    ds_read_b64_tr_b16 v[238:239], v21 offset:5120
    v_mfma_f32_32x32x16_bf16 v[144:159], v[208:211], v[196:199], v[144:159]
    s_barrier
    v_mfma_f32_32x32x16_bf16 v[160:175], v[212:215], v[192:195], v[160:175]
    v_mfma_f32_32x32x16_bf16 v[176:191], v[212:215], v[196:199], v[176:191]
    s_waitcnt lgkmcnt(0)
    v_mfma_f32_32x32x16_bf16 v[64:79], v[224:227], v[216:219], v[64:79]
    v_add_u32 v16, 24576, v16
    v_add_u32 v18, 24576, v18
    v_add_u32 v19, 24576, v19
    v_add_u32 v20, 24576, v20
    v_add_u32 v21, 24576, v21
    ds_read_b128 v[192:195], v16
    ds_read_b64_tr_b16 v[200:201], v18 offset:0
    v_mfma_f32_32x32x16_bf16 v[80:95], v[224:227], v[220:223], v[80:95]
    ds_read_b64_tr_b16 v[202:203], v18 offset:1024
    ds_read_b128 v[196:199], v16 offset:2048
    v_mfma_f32_32x32x16_bf16 v[96:111], v[228:231], v[216:219], v[96:111]
    ds_read_b64_tr_b16 v[204:205], v19 offset:0
    ds_read_b64_tr_b16 v[206:207], v19 offset:1024
    v_mfma_f32_32x32x16_bf16 v[112:127], v[228:231], v[220:223], v[112:127]
    ds_read_b64_tr_b16 v[208:209], v20 offset:0
    ds_read_b64_tr_b16 v[210:211], v20 offset:1024
    v_mfma_f32_32x32x16_bf16 v[128:143], v[232:235], v[216:219], v[128:143]
    ds_read_b64_tr_b16 v[212:213], v21 offset:0
    ds_read_b64_tr_b16 v[214:215], v21 offset:1024
    v_mfma_f32_32x32x16_bf16 v[144:159], v[232:235], v[220:223], v[144:159]
    v_mfma_f32_32x32x16_bf16 v[160:175], v[236:239], v[216:219], v[160:175]
    v_mfma_f32_32x32x16_bf16 v[176:191], v[236:239], v[220:223], v[176:191]
    s_waitcnt lgkmcnt(0)
    v_mfma_f32_32x32x16_bf16 v[64:79], v[200:203], v[192:195], v[64:79]
    v_add_u32 v17, 24576, v17
    ds_read_b128 v[216:219], v17
    ds_read_b64_tr_b16 v[224:225], v18 offset:4096
    v_mfma_f32_32x32x16_bf16 v[80:95], v[200:203], v[196:199], v[80:95]
    ds_read_b64_tr_b16 v[226:227], v18 offset:5120
    ds_read_b128 v[220:223], v17 offset:2048
    v_mfma_f32_32x32x16_bf16 v[96:111], v[204:207], v[192:195], v[96:111]
    ds_read_b64_tr_b16 v[228:229], v19 offset:4096
    ds_read_b64_tr_b16 v[230:231], v19 offset:5120
    v_mfma_f32_32x32x16_bf16 v[112:127], v[204:207], v[196:199], v[112:127]
    ds_read_b64_tr_b16 v[232:233], v20 offset:4096
    ds_read_b64_tr_b16 v[234:235], v20 offset:5120
    v_mfma_f32_32x32x16_bf16 v[128:143], v[208:211], v[192:195], v[128:143]
    ds_read_b64_tr_b16 v[236:237], v21 offset:4096
    ds_read_b64_tr_b16 v[238:239], v21 offset:5120
    v_mfma_f32_32x32x16_bf16 v[144:159], v[208:211], v[196:199], v[144:159]
    s_barrier
    v_mfma_f32_32x32x16_bf16 v[160:175], v[212:215], v[192:195], v[160:175]
    v_mfma_f32_32x32x16_bf16 v[176:191], v[212:215], v[196:199], v[176:191]
    s_waitcnt lgkmcnt(0)
    v_mfma_f32_32x32x16_bf16 v[64:79], v[224:227], v[216:219], v[64:79]
    v_add_u32 v16, 24576, v16
    v_add_u32 v18, 24576, v18
    v_add_u32 v19, 24576, v19
    v_add_u32 v20, 24576, v20
    v_add_u32 v21, 24576, v21
    ds_read_b128 v[192:195], v16
    ds_read_b64_tr_b16 v[200:201], v18 offset:0
    v_mfma_f32_32x32x16_bf16 v[80:95], v[224:227], v[220:223], v[80:95]
    ds_read_b64_tr_b16 v[202:203], v18 offset:1024
    ds_read_b128 v[196:199], v16 offset:2048
    v_mfma_f32_32x32x16_bf16 v[96:111], v[228:231], v[216:219], v[96:111]
    ds_read_b64_tr_b16 v[204:205], v19 offset:0
    ds_read_b64_tr_b16 v[206:207], v19 offset:1024
    v_mfma_f32_32x32x16_bf16 v[112:127], v[228:231], v[220:223], v[112:127]
    ds_read_b64_tr_b16 v[208:209], v20 offset:0
    ds_read_b64_tr_b16 v[210:211], v20 offset:1024
    v_mfma_f32_32x32x16_bf16 v[128:143], v[232:235], v[216:219], v[128:143]
    ds_read_b64_tr_b16 v[212:213], v21 offset:0
    ds_read_b64_tr_b16 v[214:215], v21 offset:1024
    v_mfma_f32_32x32x16_bf16 v[144:159], v[232:235], v[220:223], v[144:159]
    v_mfma_f32_32x32x16_bf16 v[160:175], v[236:239], v[216:219], v[160:175]
    v_mfma_f32_32x32x16_bf16 v[176:191], v[236:239], v[220:223], v[176:191]
    s_waitcnt lgkmcnt(0)
    v_mfma_f32_32x32x16_bf16 v[64:79], v[200:203], v[192:195], v[64:79]
    v_add_u32 v17, 24576, v17
    ds_read_b128 v[216:219], v17
    ds_read_b64_tr_b16 v[224:225], v18 offset:4096
    v_mfma_f32_32x32x16_bf16 v[80:95], v[200:203], v[196:199], v[80:95]
    ds_read_b64_tr_b16 v[226:227], v18 offset:5120
    ds_read_b128 v[220:223], v17 offset:2048
    v_mfma_f32_32x32x16_bf16 v[96:111], v[204:207], v[192:195], v[96:111]
    ds_read_b64_tr_b16 v[228:229], v19 offset:4096
    ds_read_b64_tr_b16 v[230:231], v19 offset:5120
    v_mfma_f32_32x32x16_bf16 v[112:127], v[204:207], v[196:199], v[112:127]
    ds_read_b64_tr_b16 v[232:233], v20 offset:4096
    ds_read_b64_tr_b16 v[234:235], v20 offset:5120
    v_mfma_f32_32x32x16_bf16 v[128:143], v[208:211], v[192:195], v[128:143]
    ds_read_b64_tr_b16 v[236:237], v21 offset:4096
    ds_read_b64_tr_b16 v[238:239], v21 offset:5120
    v_mfma_f32_32x32x16_bf16 v[144:159], v[208:211], v[196:199], v[144:159]
    s_barrier
    v_mfma_f32_32x32x16_bf16 v[160:175], v[212:215], v[192:195], v[160:175]
    v_mfma_f32_32x32x16_bf16 v[176:191], v[212:215], v[196:199], v[176:191]
    s_waitcnt lgkmcnt(0)
    v_mfma_f32_32x32x16_bf16 v[64:79], v[224:227], v[216:219], v[64:79]
    v_add_u32 v16, 4294868992, v16
    v_add_u32 v18, 4294868992, v18
    v_add_u32 v19, 4294868992, v19
    v_add_u32 v20, 4294868992, v20
    v_add_u32 v21, 4294868992, v21
    ds_read_b128 v[192:195], v16
    ds_read_b64_tr_b16 v[200:201], v18 offset:0
    v_mfma_f32_32x32x16_bf16 v[80:95], v[224:227], v[220:223], v[80:95]
    ds_read_b64_tr_b16 v[202:203], v18 offset:1024
    ds_read_b128 v[196:199], v16 offset:2048
    v_mfma_f32_32x32x16_bf16 v[96:111], v[228:231], v[216:219], v[96:111]
    ds_read_b64_tr_b16 v[204:205], v19 offset:0
    ds_read_b64_tr_b16 v[206:207], v19 offset:1024
    v_mfma_f32_32x32x16_bf16 v[112:127], v[228:231], v[220:223], v[112:127]
    ds_read_b64_tr_b16 v[208:209], v20 offset:0
    ds_read_b64_tr_b16 v[210:211], v20 offset:1024
    v_mfma_f32_32x32x16_bf16 v[128:143], v[232:235], v[216:219], v[128:143]
    ds_read_b64_tr_b16 v[212:213], v21 offset:0
    ds_read_b64_tr_b16 v[214:215], v21 offset:1024
    v_mfma_f32_32x32x16_bf16 v[144:159], v[232:235], v[220:223], v[144:159]
    v_mfma_f32_32x32x16_bf16 v[160:175], v[236:239], v[216:219], v[160:175]
    v_mfma_f32_32x32x16_bf16 v[176:191], v[236:239], v[220:223], v[176:191]
    s_waitcnt lgkmcnt(0)
    v_mfma_f32_32x32x16_bf16 v[64:79], v[200:203], v[192:195], v[64:79]
    v_add_u32 v17, 4294868992, v17
    ds_read_b128 v[216:219], v17
    ds_read_b64_tr_b16 v[224:225], v18 offset:4096
    v_mfma_f32_32x32x16_bf16 v[80:95], v[200:203], v[196:199], v[80:95]
    ds_read_b64_tr_b16 v[226:227], v18 offset:5120
    ds_read_b128 v[220:223], v17 offset:2048
    v_mfma_f32_32x32x16_bf16 v[96:111], v[204:207], v[192:195], v[96:111]
    ds_read_b64_tr_b16 v[228:229], v19 offset:4096
    ds_read_b64_tr_b16 v[230:231], v19 offset:5120
    v_mfma_f32_32x32x16_bf16 v[112:127], v[204:207], v[196:199], v[112:127]
    ds_read_b64_tr_b16 v[232:233], v20 offset:4096
    ds_read_b64_tr_b16 v[234:235], v20 offset:5120
    v_mfma_f32_32x32x16_bf16 v[128:143], v[208:211], v[192:195], v[128:143]
    ds_read_b64_tr_b16 v[236:237], v21 offset:4096
    ds_read_b64_tr_b16 v[238:239], v21 offset:5120
    v_mfma_f32_32x32x16_bf16 v[144:159], v[208:211], v[196:199], v[144:159]
    s_barrier
    v_mfma_f32_32x32x16_bf16 v[160:175], v[212:215], v[192:195], v[160:175]
    v_mfma_f32_32x32x16_bf16 v[176:191], v[212:215], v[196:199], v[176:191]
    s_waitcnt lgkmcnt(0)
    v_mfma_f32_32x32x16_bf16 v[64:79], v[224:227], v[216:219], v[64:79]
    v_add_u32 v16, 24576, v16
    v_add_u32 v18, 24576, v18
    v_add_u32 v19, 24576, v19
    v_add_u32 v20, 24576, v20
    v_add_u32 v21, 24576, v21
    ds_read_b128 v[192:195], v16
    ds_read_b64_tr_b16 v[200:201], v18 offset:0
    v_mfma_f32_32x32x16_bf16 v[80:95], v[224:227], v[220:223], v[80:95]
    ds_read_b64_tr_b16 v[202:203], v18 offset:1024
    ds_read_b128 v[196:199], v16 offset:2048
    v_mfma_f32_32x32x16_bf16 v[96:111], v[228:231], v[216:219], v[96:111]
    ds_read_b64_tr_b16 v[204:205], v19 offset:0
    ds_read_b64_tr_b16 v[206:207], v19 offset:1024
    v_mfma_f32_32x32x16_bf16 v[112:127], v[228:231], v[220:223], v[112:127]
    ds_read_b64_tr_b16 v[208:209], v20 offset:0
    ds_read_b64_tr_b16 v[210:211], v20 offset:1024
    v_mfma_f32_32x32x16_bf16 v[128:143], v[232:235], v[216:219], v[128:143]
    ds_read_b64_tr_b16 v[212:213], v21 offset:0
    ds_read_b64_tr_b16 v[214:215], v21 offset:1024
    v_mfma_f32_32x32x16_bf16 v[144:159], v[232:235], v[220:223], v[144:159]
    v_mfma_f32_32x32x16_bf16 v[160:175], v[236:239], v[216:219], v[160:175]
    v_mfma_f32_32x32x16_bf16 v[176:191], v[236:239], v[220:223], v[176:191]
    s_waitcnt lgkmcnt(0)
    v_mfma_f32_32x32x16_bf16 v[64:79], v[200:203], v[192:195], v[64:79]
    v_add_u32 v17, 24576, v17
    ds_read_b128 v[216:219], v17
    ds_read_b64_tr_b16 v[224:225], v18 offset:4096
    v_mfma_f32_32x32x16_bf16 v[80:95], v[200:203], v[196:199], v[80:95]
    ds_read_b64_tr_b16 v[226:227], v18 offset:5120
    ds_read_b128 v[220:223], v17 offset:2048
    v_mfma_f32_32x32x16_bf16 v[96:111], v[204:207], v[192:195], v[96:111]
    ds_read_b64_tr_b16 v[228:229], v19 offset:4096
    ds_read_b64_tr_b16 v[230:231], v19 offset:5120
    v_mfma_f32_32x32x16_bf16 v[112:127], v[204:207], v[196:199], v[112:127]
    ds_read_b64_tr_b16 v[232:233], v20 offset:4096
    ds_read_b64_tr_b16 v[234:235], v20 offset:5120
    v_mfma_f32_32x32x16_bf16 v[128:143], v[208:211], v[192:195], v[128:143]
    ds_read_b64_tr_b16 v[236:237], v21 offset:4096
    ds_read_b64_tr_b16 v[238:239], v21 offset:5120
    v_mfma_f32_32x32x16_bf16 v[144:159], v[208:211], v[196:199], v[144:159]
    s_barrier
    v_mfma_f32_32x32x16_bf16 v[160:175], v[212:215], v[192:195], v[160:175]
    v_mfma_f32_32x32x16_bf16 v[176:191], v[212:215], v[196:199], v[176:191]
    s_waitcnt lgkmcnt(0)
    v_mfma_f32_32x32x16_bf16 v[64:79], v[224:227], v[216:219], v[64:79]
    v_add_u32 v16, 24576, v16
    v_add_u32 v18, 24576, v18
    v_add_u32 v19, 24576, v19
    v_add_u32 v20, 24576, v20
    v_add_u32 v21, 24576, v21
    ds_read_b128 v[192:195], v16
    ds_read_b64_tr_b16 v[200:201], v18 offset:0
    v_mfma_f32_32x32x16_bf16 v[80:95], v[224:227], v[220:223], v[80:95]
    ds_read_b64_tr_b16 v[202:203], v18 offset:1024
    ds_read_b128 v[196:199], v16 offset:2048
    v_mfma_f32_32x32x16_bf16 v[96:111], v[228:231], v[216:219], v[96:111]
    ds_read_b64_tr_b16 v[204:205], v19 offset:0
    ds_read_b64_tr_b16 v[206:207], v19 offset:1024
    v_mfma_f32_32x32x16_bf16 v[112:127], v[228:231], v[220:223], v[112:127]
    ds_read_b64_tr_b16 v[208:209], v20 offset:0
    ds_read_b64_tr_b16 v[210:211], v20 offset:1024
    v_mfma_f32_32x32x16_bf16 v[128:143], v[232:235], v[216:219], v[128:143]
    ds_read_b64_tr_b16 v[212:213], v21 offset:0
    ds_read_b64_tr_b16 v[214:215], v21 offset:1024
    v_mfma_f32_32x32x16_bf16 v[144:159], v[232:235], v[220:223], v[144:159]
    v_mfma_f32_32x32x16_bf16 v[160:175], v[236:239], v[216:219], v[160:175]
    v_mfma_f32_32x32x16_bf16 v[176:191], v[236:239], v[220:223], v[176:191]
    s_waitcnt lgkmcnt(0)
    v_mfma_f32_32x32x16_bf16 v[64:79], v[200:203], v[192:195], v[64:79]
    v_add_u32 v17, 24576, v17
    ds_read_b128 v[216:219], v17
    ds_read_b64_tr_b16 v[224:225], v18 offset:4096
    v_mfma_f32_32x32x16_bf16 v[80:95], v[200:203], v[196:199], v[80:95]
    ds_read_b64_tr_b16 v[226:227], v18 offset:5120
    ds_read_b128 v[220:223], v17 offset:2048
    v_mfma_f32_32x32x16_bf16 v[96:111], v[204:207], v[192:195], v[96:111]
    ds_read_b64_tr_b16 v[228:229], v19 offset:4096
    ds_read_b64_tr_b16 v[230:231], v19 offset:5120
    v_mfma_f32_32x32x16_bf16 v[112:127], v[204:207], v[196:199], v[112:127]
    ds_read_b64_tr_b16 v[232:233], v20 offset:4096
    ds_read_b64_tr_b16 v[234:235], v20 offset:5120
    v_mfma_f32_32x32x16_bf16 v[128:143], v[208:211], v[192:195], v[128:143]
    ds_read_b64_tr_b16 v[236:237], v21 offset:4096
    ds_read_b64_tr_b16 v[238:239], v21 offset:5120
    v_mfma_f32_32x32x16_bf16 v[144:159], v[208:211], v[196:199], v[144:159]
    s_barrier
    v_mfma_f32_32x32x16_bf16 v[160:175], v[212:215], v[192:195], v[160:175]
    v_mfma_f32_32x32x16_bf16 v[176:191], v[212:215], v[196:199], v[176:191]
    s_waitcnt lgkmcnt(0)
    v_mfma_f32_32x32x16_bf16 v[64:79], v[224:227], v[216:219], v[64:79]
    v_add_u32 v16, 24576, v16
    v_add_u32 v18, 24576, v18
    v_add_u32 v19, 24576, v19
    v_add_u32 v20, 24576, v20
    v_add_u32 v21, 24576, v21
    ds_read_b128 v[192:195], v16
    ds_read_b64_tr_b16 v[200:201], v18 offset:0
    v_mfma_f32_32x32x16_bf16 v[80:95], v[224:227], v[220:223], v[80:95]
    ds_read_b64_tr_b16 v[202:203], v18 offset:1024
    ds_read_b128 v[196:199], v16 offset:2048
    v_mfma_f32_32x32x16_bf16 v[96:111], v[228:231], v[216:219], v[96:111]
    ds_read_b64_tr_b16 v[204:205], v19 offset:0
    ds_read_b64_tr_b16 v[206:207], v19 offset:1024
    v_mfma_f32_32x32x16_bf16 v[112:127], v[228:231], v[220:223], v[112:127]
    ds_read_b64_tr_b16 v[208:209], v20 offset:0
    ds_read_b64_tr_b16 v[210:211], v20 offset:1024
    v_mfma_f32_32x32x16_bf16 v[128:143], v[232:235], v[216:219], v[128:143]
    ds_read_b64_tr_b16 v[212:213], v21 offset:0
    ds_read_b64_tr_b16 v[214:215], v21 offset:1024
    v_mfma_f32_32x32x16_bf16 v[144:159], v[232:235], v[220:223], v[144:159]
    v_mfma_f32_32x32x16_bf16 v[160:175], v[236:239], v[216:219], v[160:175]
    v_mfma_f32_32x32x16_bf16 v[176:191], v[236:239], v[220:223], v[176:191]
    s_waitcnt lgkmcnt(0)
    v_mfma_f32_32x32x16_bf16 v[64:79], v[200:203], v[192:195], v[64:79]
    v_add_u32 v17, 24576, v17
    ds_read_b128 v[216:219], v17
    ds_read_b64_tr_b16 v[224:225], v18 offset:4096
    v_mfma_f32_32x32x16_bf16 v[80:95], v[200:203], v[196:199], v[80:95]
    ds_read_b64_tr_b16 v[226:227], v18 offset:5120
    ds_read_b128 v[220:223], v17 offset:2048
    v_mfma_f32_32x32x16_bf16 v[96:111], v[204:207], v[192:195], v[96:111]
    ds_read_b64_tr_b16 v[228:229], v19 offset:4096
    ds_read_b64_tr_b16 v[230:231], v19 offset:5120
    v_mfma_f32_32x32x16_bf16 v[112:127], v[204:207], v[196:199], v[112:127]
    ds_read_b64_tr_b16 v[232:233], v20 offset:4096
    ds_read_b64_tr_b16 v[234:235], v20 offset:5120
    v_mfma_f32_32x32x16_bf16 v[128:143], v[208:211], v[192:195], v[128:143]
    ds_read_b64_tr_b16 v[236:237], v21 offset:4096
    ds_read_b64_tr_b16 v[238:239], v21 offset:5120
    v_mfma_f32_32x32x16_bf16 v[144:159], v[208:211], v[196:199], v[144:159]
    s_barrier
    v_mfma_f32_32x32x16_bf16 v[160:175], v[212:215], v[192:195], v[160:175]
    v_mfma_f32_32x32x16_bf16 v[176:191], v[212:215], v[196:199], v[176:191]
    s_waitcnt lgkmcnt(0)
    v_mfma_f32_32x32x16_bf16 v[64:79], v[224:227], v[216:219], v[64:79]
    v_add_u32 v16, 24576, v16
    v_add_u32 v18, 24576, v18
    v_add_u32 v19, 24576, v19
    v_add_u32 v20, 24576, v20
    v_add_u32 v21, 24576, v21
    ds_read_b128 v[192:195], v16
    ds_read_b64_tr_b16 v[200:201], v18 offset:0
    v_mfma_f32_32x32x16_bf16 v[80:95], v[224:227], v[220:223], v[80:95]
    ds_read_b64_tr_b16 v[202:203], v18 offset:1024
    ds_read_b128 v[196:199], v16 offset:2048
    v_mfma_f32_32x32x16_bf16 v[96:111], v[228:231], v[216:219], v[96:111]
    ds_read_b64_tr_b16 v[204:205], v19 offset:0
    ds_read_b64_tr_b16 v[206:207], v19 offset:1024
    v_mfma_f32_32x32x16_bf16 v[112:127], v[228:231], v[220:223], v[112:127]
    ds_read_b64_tr_b16 v[208:209], v20 offset:0
    ds_read_b64_tr_b16 v[210:211], v20 offset:1024
    v_mfma_f32_32x32x16_bf16 v[128:143], v[232:235], v[216:219], v[128:143]
    ds_read_b64_tr_b16 v[212:213], v21 offset:0
    ds_read_b64_tr_b16 v[214:215], v21 offset:1024
    v_mfma_f32_32x32x16_bf16 v[144:159], v[232:235], v[220:223], v[144:159]
    v_mfma_f32_32x32x16_bf16 v[160:175], v[236:239], v[216:219], v[160:175]
    v_mfma_f32_32x32x16_bf16 v[176:191], v[236:239], v[220:223], v[176:191]
    s_waitcnt lgkmcnt(0)
    v_mfma_f32_32x32x16_bf16 v[64:79], v[200:203], v[192:195], v[64:79]
    v_add_u32 v17, 24576, v17
    ds_read_b128 v[216:219], v17
    ds_read_b64_tr_b16 v[224:225], v18 offset:4096
    v_mfma_f32_32x32x16_bf16 v[80:95], v[200:203], v[196:199], v[80:95]
    ds_read_b64_tr_b16 v[226:227], v18 offset:5120
    ds_read_b128 v[220:223], v17 offset:2048
    v_mfma_f32_32x32x16_bf16 v[96:111], v[204:207], v[192:195], v[96:111]
    ds_read_b64_tr_b16 v[228:229], v19 offset:4096
    ds_read_b64_tr_b16 v[230:231], v19 offset:5120
    v_mfma_f32_32x32x16_bf16 v[112:127], v[204:207], v[196:199], v[112:127]
    ds_read_b64_tr_b16 v[232:233], v20 offset:4096
    ds_read_b64_tr_b16 v[234:235], v20 offset:5120
    v_mfma_f32_32x32x16_bf16 v[128:143], v[208:211], v[192:195], v[128:143]
    ds_read_b64_tr_b16 v[236:237], v21 offset:4096
    ds_read_b64_tr_b16 v[238:239], v21 offset:5120
    v_mfma_f32_32x32x16_bf16 v[144:159], v[208:211], v[196:199], v[144:159]
    s_barrier
    v_mfma_f32_32x32x16_bf16 v[160:175], v[212:215], v[192:195], v[160:175]
    v_mfma_f32_32x32x16_bf16 v[176:191], v[212:215], v[196:199], v[176:191]
    s_waitcnt lgkmcnt(0)
    v_mfma_f32_32x32x16_bf16 v[64:79], v[224:227], v[216:219], v[64:79]
    v_add_u32 v16, 4294868992, v16
    v_add_u32 v18, 4294868992, v18
    v_add_u32 v19, 4294868992, v19
    v_add_u32 v20, 4294868992, v20
    v_add_u32 v21, 4294868992, v21
    ds_read_b128 v[192:195], v16
    ds_read_b64_tr_b16 v[200:201], v18 offset:0
    v_mfma_f32_32x32x16_bf16 v[80:95], v[224:227], v[220:223], v[80:95]
    ds_read_b64_tr_b16 v[202:203], v18 offset:1024
    ds_read_b128 v[196:199], v16 offset:2048
    v_mfma_f32_32x32x16_bf16 v[96:111], v[228:231], v[216:219], v[96:111]
    ds_read_b64_tr_b16 v[204:205], v19 offset:0
    ds_read_b64_tr_b16 v[206:207], v19 offset:1024
    v_mfma_f32_32x32x16_bf16 v[112:127], v[228:231], v[220:223], v[112:127]
    ds_read_b64_tr_b16 v[208:209], v20 offset:0
    ds_read_b64_tr_b16 v[210:211], v20 offset:1024
    v_mfma_f32_32x32x16_bf16 v[128:143], v[232:235], v[216:219], v[128:143]
    ds_read_b64_tr_b16 v[212:213], v21 offset:0
    ds_read_b64_tr_b16 v[214:215], v21 offset:1024
    v_mfma_f32_32x32x16_bf16 v[144:159], v[232:235], v[220:223], v[144:159]
    v_mfma_f32_32x32x16_bf16 v[160:175], v[236:239], v[216:219], v[160:175]
    v_mfma_f32_32x32x16_bf16 v[176:191], v[236:239], v[220:223], v[176:191]
    s_waitcnt lgkmcnt(0)
    v_mfma_f32_32x32x16_bf16 v[64:79], v[200:203], v[192:195], v[64:79]
    v_add_u32 v17, 4294868992, v17
    ds_read_b128 v[216:219], v17
    ds_read_b64_tr_b16 v[224:225], v18 offset:4096
    v_mfma_f32_32x32x16_bf16 v[80:95], v[200:203], v[196:199], v[80:95]
    ds_read_b64_tr_b16 v[226:227], v18 offset:5120
    ds_read_b128 v[220:223], v17 offset:2048
    v_mfma_f32_32x32x16_bf16 v[96:111], v[204:207], v[192:195], v[96:111]
    ds_read_b64_tr_b16 v[228:229], v19 offset:4096
    ds_read_b64_tr_b16 v[230:231], v19 offset:5120
    v_mfma_f32_32x32x16_bf16 v[112:127], v[204:207], v[196:199], v[112:127]
    ds_read_b64_tr_b16 v[232:233], v20 offset:4096
    ds_read_b64_tr_b16 v[234:235], v20 offset:5120
    v_mfma_f32_32x32x16_bf16 v[128:143], v[208:211], v[192:195], v[128:143]
    ds_read_b64_tr_b16 v[236:237], v21 offset:4096
    ds_read_b64_tr_b16 v[238:239], v21 offset:5120
    v_mfma_f32_32x32x16_bf16 v[144:159], v[208:211], v[196:199], v[144:159]
    s_barrier
    v_mfma_f32_32x32x16_bf16 v[160:175], v[212:215], v[192:195], v[160:175]
    v_mfma_f32_32x32x16_bf16 v[176:191], v[212:215], v[196:199], v[176:191]
    s_waitcnt lgkmcnt(0)
    v_mfma_f32_32x32x16_bf16 v[64:79], v[224:227], v[216:219], v[64:79]
    v_add_u32 v16, 24576, v16
    v_add_u32 v18, 24576, v18
    v_add_u32 v19, 24576, v19
    v_add_u32 v20, 24576, v20
    v_add_u32 v21, 24576, v21
    ds_read_b128 v[192:195], v16
    ds_read_b64_tr_b16 v[200:201], v18 offset:0
    v_mfma_f32_32x32x16_bf16 v[80:95], v[224:227], v[220:223], v[80:95]
    ds_read_b64_tr_b16 v[202:203], v18 offset:1024
    ds_read_b128 v[196:199], v16 offset:2048
    v_mfma_f32_32x32x16_bf16 v[96:111], v[228:231], v[216:219], v[96:111]
    ds_read_b64_tr_b16 v[204:205], v19 offset:0
    ds_read_b64_tr_b16 v[206:207], v19 offset:1024
    v_mfma_f32_32x32x16_bf16 v[112:127], v[228:231], v[220:223], v[112:127]
    ds_read_b64_tr_b16 v[208:209], v20 offset:0
    ds_read_b64_tr_b16 v[210:211], v20 offset:1024
    v_mfma_f32_32x32x16_bf16 v[128:143], v[232:235], v[216:219], v[128:143]
    ds_read_b64_tr_b16 v[212:213], v21 offset:0
    ds_read_b64_tr_b16 v[214:215], v21 offset:1024
    v_mfma_f32_32x32x16_bf16 v[144:159], v[232:235], v[220:223], v[144:159]
    v_mfma_f32_32x32x16_bf16 v[160:175], v[236:239], v[216:219], v[160:175]
    v_mfma_f32_32x32x16_bf16 v[176:191], v[236:239], v[220:223], v[176:191]
    s_waitcnt lgkmcnt(0)
    v_mfma_f32_32x32x16_bf16 v[64:79], v[200:203], v[192:195], v[64:79]
    v_add_u32 v17, 24576, v17
    ds_read_b128 v[216:219], v17
    ds_read_b64_tr_b16 v[224:225], v18 offset:4096
    v_mfma_f32_32x32x16_bf16 v[80:95], v[200:203], v[196:199], v[80:95]
    ds_read_b64_tr_b16 v[226:227], v18 offset:5120
    ds_read_b128 v[220:223], v17 offset:2048
    v_mfma_f32_32x32x16_bf16 v[96:111], v[204:207], v[192:195], v[96:111]
    ds_read_b64_tr_b16 v[228:229], v19 offset:4096
    ds_read_b64_tr_b16 v[230:231], v19 offset:5120
    v_mfma_f32_32x32x16_bf16 v[112:127], v[204:207], v[196:199], v[112:127]
    ds_read_b64_tr_b16 v[232:233], v20 offset:4096
    ds_read_b64_tr_b16 v[234:235], v20 offset:5120
    v_mfma_f32_32x32x16_bf16 v[128:143], v[208:211], v[192:195], v[128:143]
    ds_read_b64_tr_b16 v[236:237], v21 offset:4096
    ds_read_b64_tr_b16 v[238:239], v21 offset:5120
    v_mfma_f32_32x32x16_bf16 v[144:159], v[208:211], v[196:199], v[144:159]
    s_barrier
    v_mfma_f32_32x32x16_bf16 v[160:175], v[212:215], v[192:195], v[160:175]
    v_mfma_f32_32x32x16_bf16 v[176:191], v[212:215], v[196:199], v[176:191]
    s_waitcnt lgkmcnt(0)
    v_mfma_f32_32x32x16_bf16 v[64:79], v[224:227], v[216:219], v[64:79]
    v_add_u32 v16, 24576, v16
    v_add_u32 v18, 24576, v18
    v_add_u32 v19, 24576, v19
    v_add_u32 v20, 24576, v20
    v_add_u32 v21, 24576, v21
    ds_read_b128 v[192:195], v16
    ds_read_b64_tr_b16 v[200:201], v18 offset:0
    v_mfma_f32_32x32x16_bf16 v[80:95], v[224:227], v[220:223], v[80:95]
    ds_read_b64_tr_b16 v[202:203], v18 offset:1024
    ds_read_b128 v[196:199], v16 offset:2048
    v_mfma_f32_32x32x16_bf16 v[96:111], v[228:231], v[216:219], v[96:111]
    ds_read_b64_tr_b16 v[204:205], v19 offset:0
    ds_read_b64_tr_b16 v[206:207], v19 offset:1024
    v_mfma_f32_32x32x16_bf16 v[112:127], v[228:231], v[220:223], v[112:127]
    ds_read_b64_tr_b16 v[208:209], v20 offset:0
    ds_read_b64_tr_b16 v[210:211], v20 offset:1024
    v_mfma_f32_32x32x16_bf16 v[128:143], v[232:235], v[216:219], v[128:143]
    ds_read_b64_tr_b16 v[212:213], v21 offset:0
    ds_read_b64_tr_b16 v[214:215], v21 offset:1024
    v_mfma_f32_32x32x16_bf16 v[144:159], v[232:235], v[220:223], v[144:159]
    v_mfma_f32_32x32x16_bf16 v[160:175], v[236:239], v[216:219], v[160:175]
    v_mfma_f32_32x32x16_bf16 v[176:191], v[236:239], v[220:223], v[176:191]
    s_waitcnt lgkmcnt(0)
    v_mfma_f32_32x32x16_bf16 v[64:79], v[200:203], v[192:195], v[64:79]
    v_mov_b32 v62, 12
    s_mov_b64 exec, 1
    ds_write_b32 v60, v62
    s_mov_b64 exec, -1
    v_add_u32 v17, 24576, v17
    ds_read_b128 v[216:219], v17
    ds_read_b64_tr_b16 v[224:225], v18 offset:4096
    v_mfma_f32_32x32x16_bf16 v[80:95], v[200:203], v[196:199], v[80:95]
    ds_read_b64_tr_b16 v[226:227], v18 offset:5120
    ds_read_b128 v[220:223], v17 offset:2048
    v_mfma_f32_32x32x16_bf16 v[96:111], v[204:207], v[192:195], v[96:111]
    ds_read_b64_tr_b16 v[228:229], v19 offset:4096
    ds_read_b64_tr_b16 v[230:231], v19 offset:5120
    v_mfma_f32_32x32x16_bf16 v[112:127], v[204:207], v[196:199], v[112:127]
    ds_read_b64_tr_b16 v[232:233], v20 offset:4096
    ds_read_b64_tr_b16 v[234:235], v20 offset:5120
    v_mfma_f32_32x32x16_bf16 v[128:143], v[208:211], v[192:195], v[128:143]
    ds_read_b64_tr_b16 v[236:237], v21 offset:4096
    ds_read_b64_tr_b16 v[238:239], v21 offset:5120
    v_mfma_f32_32x32x16_bf16 v[144:159], v[208:211], v[196:199], v[144:159]
    v_mfma_f32_32x32x16_bf16 v[160:175], v[212:215], v[192:195], v[160:175]
    v_mfma_f32_32x32x16_bf16 v[176:191], v[212:215], v[196:199], v[176:191]
    s_waitcnt lgkmcnt(0)
    v_mfma_f32_32x32x16_bf16 v[64:79], v[224:227], v[216:219], v[64:79]
    v_add_u32 v16, 24576, v16
    v_add_u32 v18, 24576, v18
    v_add_u32 v19, 24576, v19
    v_add_u32 v20, 24576, v20
    v_add_u32 v21, 24576, v21
    ds_read_b128 v[192:195], v16
    ds_read_b64_tr_b16 v[200:201], v18 offset:0
    v_mfma_f32_32x32x16_bf16 v[80:95], v[224:227], v[220:223], v[80:95]
    ds_read_b64_tr_b16 v[202:203], v18 offset:1024
    ds_read_b128 v[196:199], v16 offset:2048
    v_mfma_f32_32x32x16_bf16 v[96:111], v[228:231], v[216:219], v[96:111]
    ds_read_b64_tr_b16 v[204:205], v19 offset:0
    ds_read_b64_tr_b16 v[206:207], v19 offset:1024
    v_mfma_f32_32x32x16_bf16 v[112:127], v[228:231], v[220:223], v[112:127]
    ds_read_b64_tr_b16 v[208:209], v20 offset:0
    ds_read_b64_tr_b16 v[210:211], v20 offset:1024
    v_mfma_f32_32x32x16_bf16 v[128:143], v[232:235], v[216:219], v[128:143]
    ds_read_b64_tr_b16 v[212:213], v21 offset:0
    ds_read_b64_tr_b16 v[214:215], v21 offset:1024
    v_mfma_f32_32x32x16_bf16 v[144:159], v[232:235], v[220:223], v[144:159]
    v_mfma_f32_32x32x16_bf16 v[160:175], v[236:239], v[216:219], v[160:175]
    v_mfma_f32_32x32x16_bf16 v[176:191], v[236:239], v[220:223], v[176:191]
    s_waitcnt lgkmcnt(0)
    v_mfma_f32_32x32x16_bf16 v[64:79], v[200:203], v[192:195], v[64:79]
    v_mov_b32 v62, 13
    s_mov_b64 exec, 1
    ds_write_b32 v60, v62
    s_mov_b64 exec, -1
    v_add_u32 v17, 24576, v17
    ds_read_b128 v[216:219], v17
    ds_read_b64_tr_b16 v[224:225], v18 offset:4096
    v_mfma_f32_32x32x16_bf16 v[80:95], v[200:203], v[196:199], v[80:95]
    ds_read_b64_tr_b16 v[226:227], v18 offset:5120
    ds_read_b128 v[220:223], v17 offset:2048
    v_mfma_f32_32x32x16_bf16 v[96:111], v[204:207], v[192:195], v[96:111]
    ds_read_b64_tr_b16 v[228:229], v19 offset:4096
    ds_read_b64_tr_b16 v[230:231], v19 offset:5120
    v_mfma_f32_32x32x16_bf16 v[112:127], v[204:207], v[196:199], v[112:127]
    ds_read_b64_tr_b16 v[232:233], v20 offset:4096
    ds_read_b64_tr_b16 v[234:235], v20 offset:5120
    v_mfma_f32_32x32x16_bf16 v[128:143], v[208:211], v[192:195], v[128:143]
    ds_read_b64_tr_b16 v[236:237], v21 offset:4096
    ds_read_b64_tr_b16 v[238:239], v21 offset:5120
    v_mfma_f32_32x32x16_bf16 v[144:159], v[208:211], v[196:199], v[144:159]
    v_mfma_f32_32x32x16_bf16 v[160:175], v[212:215], v[192:195], v[160:175]
    v_mfma_f32_32x32x16_bf16 v[176:191], v[212:215], v[196:199], v[176:191]
    s_waitcnt lgkmcnt(0)
    v_mfma_f32_32x32x16_bf16 v[64:79], v[224:227], v[216:219], v[64:79]
    v_mfma_f32_32x32x16_bf16 v[80:95], v[224:227], v[220:223], v[80:95]
    v_mov_b32 v62, 14
    s_mov_b64 exec, 1
    ds_write_b32 v60, v62
    s_mov_b64 exec, -1
    s_mov_b32 s58, 0x3
    v_lshlrev_b32 v2, 2, v1
    v_add_u32 v2, 163616, v2
    v_min_u32 v2, 163836, v2
    s_mov_b32 s67, 0
L_LW_17:
    ds_read_b32 v3, v2
    s_waitcnt lgkmcnt(0)
    v_cmp_le_u32 vcc, 1, v3
    s_nop 3
    s_and_b32 s57, vcc_lo, s58
    s_cmp_eq_u32 s57, s58
    s_cbranch_scc1 L_LO_18
    s_add_u32 s67, s67, 1
    s_cmp_lt_u32 s67, 800000
    s_cbranch_scc1 L_LW_17
L_LO_18:
    ds_read_b128 v[8:11], v56
    ds_read_b128 v[12:15], v56 offset:512
    ds_read_b64 v[32:33], v57 offset:0
    ds_read_b64 v[36:37], v57 offset:128
    ds_read_b64 v[40:41], v57 offset:256
    ds_read_b64 v[44:45], v57 offset:384
    v_mfma_f32_32x32x16_bf16 v[96:111], v[228:231], v[216:219], v[96:111]
    v_mfma_f32_32x32x16_bf16 v[112:127], v[228:231], v[220:223], v[112:127]
    v_mfma_f32_32x32x16_bf16 v[128:143], v[232:235], v[216:219], v[128:143]
    v_mfma_f32_32x32x16_bf16 v[144:159], v[232:235], v[220:223], v[144:159]
    s_waitcnt lgkmcnt(0)
    v_cmp_gt_u32 vcc, 32, v1
    s_nop 1
    v_cndmask_b32 v48, 0, v8, vcc
    v_and_b32 v49, 0xffff, v48
    v_mov_b32 v8, v9
    v_mov_b32 v11, v10
    v_cndmask_b32 v52, 0, v12, vcc
    v_and_b32 v53, 0xffff, v52
    v_mov_b32 v12, v13
    v_mov_b32 v15, v14
    v_mfma_f32_32x32x16_bf16 v[160:175], v[236:239], v[216:219], v[160:175]
    v_mfma_f32_32x32x16_bf16 v[176:191], v[236:239], v[220:223], v[176:191]
    v_mfma_f32_32x32x16_bf16 v[64:79], v[32:35], v[48:51], v[64:79]
    v_mfma_f32_32x32x16_bf16 v[80:95], v[32:35], v[52:55], v[80:95]
    v_mfma_f32_32x32x16_bf16 v[96:111], v[36:39], v[48:51], v[96:111]
    v_mfma_f32_32x32x16_bf16 v[112:127], v[36:39], v[52:55], v[112:127]
    v_mfma_f32_32x32x16_bf16 v[128:143], v[40:43], v[48:51], v[128:143]
    v_mfma_f32_32x32x16_bf16 v[144:159], v[40:43], v[52:55], v[144:159]
    v_mfma_f32_32x32x16_bf16 v[160:175], v[44:47], v[48:51], v[160:175]
    v_mfma_f32_32x32x16_bf16 v[176:191], v[44:47], v[52:55], v[176:191]
    s_nop 7
    v_pk_mul_f32 v[72:73], v[64:65], v[72:73]
    v_pk_mul_f32 v[64:65], v[64:65], v[8:9]
    v_pk_mul_f32 v[74:75], v[66:67], v[74:75]
    v_pk_mul_f32 v[66:67], v[66:67], v[8:9]
    v_pk_mul_f32 v[76:77], v[68:69], v[76:77]
    v_pk_mul_f32 v[68:69], v[68:69], v[8:9]
    v_pk_mul_f32 v[78:79], v[70:71], v[78:79]
    v_pk_mul_f32 v[70:71], v[70:71], v[8:9]
    v_exp_f32 v64, v64
    v_exp_f32 v65, v65
    v_exp_f32 v66, v66
    v_exp_f32 v67, v67
    v_exp_f32 v68, v68
    v_exp_f32 v69, v69
    v_exp_f32 v70, v70
    v_exp_f32 v71, v71
    v_pk_fma_f32 v[64:65], v[64:65], v[10:11], v[10:11]
    v_pk_fma_f32 v[66:67], v[66:67], v[10:11], v[10:11]
    v_pk_fma_f32 v[68:69], v[68:69], v[10:11], v[10:11]
    v_pk_fma_f32 v[70:71], v[70:71], v[10:11], v[10:11]
    v_rcp_f32 v64, v64
    v_rcp_f32 v65, v65
    v_rcp_f32 v66, v66
    v_rcp_f32 v67, v67
    v_rcp_f32 v68, v68
    v_rcp_f32 v69, v69
    v_rcp_f32 v70, v70
    v_rcp_f32 v71, v71
    v_pk_mul_f32 v[72:73], v[64:65], v[72:73]
    v_pk_mul_f32 v[74:75], v[66:67], v[74:75]
    v_pk_mul_f32 v[76:77], v[68:69], v[76:77]
    v_pk_mul_f32 v[78:79], v[70:71], v[78:79]
    v_cvt_pk_bf16_f32 v32, v72, v73
    v_cvt_pk_bf16_f32 v33, v74, v75
    v_cvt_pk_bf16_f32 v34, v76, v77
    v_cvt_pk_bf16_f32 v35, v78, v79
    buffer_store_dwordx4 v[32:35], v22, s[16:19], s64 offen offset:0 sc1
    v_pk_mul_f32 v[88:89], v[80:81], v[88:89]
    v_pk_mul_f32 v[80:81], v[80:81], v[12:13]
    v_pk_mul_f32 v[90:91], v[82:83], v[90:91]
    v_pk_mul_f32 v[82:83], v[82:83], v[12:13]
    v_pk_mul_f32 v[92:93], v[84:85], v[92:93]
    v_pk_mul_f32 v[84:85], v[84:85], v[12:13]
    v_pk_mul_f32 v[94:95], v[86:87], v[94:95]
    v_pk_mul_f32 v[86:87], v[86:87], v[12:13]
    v_exp_f32 v80, v80
    v_exp_f32 v81, v81
    v_exp_f32 v82, v82
    v_exp_f32 v83, v83
    v_exp_f32 v84, v84
    v_exp_f32 v85, v85
    v_exp_f32 v86, v86
    v_exp_f32 v87, v87
    v_pk_fma_f32 v[80:81], v[80:81], v[14:15], v[14:15]
    v_pk_fma_f32 v[82:83], v[82:83], v[14:15], v[14:15]
    v_pk_fma_f32 v[84:85], v[84:85], v[14:15], v[14:15]
    v_pk_fma_f32 v[86:87], v[86:87], v[14:15], v[14:15]
    v_rcp_f32 v80, v80
    v_rcp_f32 v81, v81
    v_rcp_f32 v82, v82
    v_rcp_f32 v83, v83
    v_rcp_f32 v84, v84
    v_rcp_f32 v85, v85
    v_rcp_f32 v86, v86
    v_rcp_f32 v87, v87
    v_pk_mul_f32 v[88:89], v[80:81], v[88:89]
    v_pk_mul_f32 v[90:91], v[82:83], v[90:91]
    v_pk_mul_f32 v[92:93], v[84:85], v[92:93]
    v_pk_mul_f32 v[94:95], v[86:87], v[94:95]
    v_cvt_pk_bf16_f32 v36, v88, v89
    v_cvt_pk_bf16_f32 v37, v90, v91
    v_cvt_pk_bf16_f32 v38, v92, v93
    v_cvt_pk_bf16_f32 v39, v94, v95
    buffer_store_dwordx4 v[36:39], v22, s[16:19], s65 offen offset:0 sc1
    v_pk_mul_f32 v[104:105], v[96:97], v[104:105]
    v_pk_mul_f32 v[96:97], v[96:97], v[8:9]
    v_pk_mul_f32 v[106:107], v[98:99], v[106:107]
    v_pk_mul_f32 v[98:99], v[98:99], v[8:9]
    v_pk_mul_f32 v[108:109], v[100:101], v[108:109]
    v_pk_mul_f32 v[100:101], v[100:101], v[8:9]
    v_pk_mul_f32 v[110:111], v[102:103], v[110:111]
    v_pk_mul_f32 v[102:103], v[102:103], v[8:9]
    v_exp_f32 v96, v96
    v_exp_f32 v97, v97
    v_exp_f32 v98, v98
    v_exp_f32 v99, v99
    v_exp_f32 v100, v100
    v_exp_f32 v101, v101
    v_exp_f32 v102, v102
    v_exp_f32 v103, v103
    v_pk_fma_f32 v[96:97], v[96:97], v[10:11], v[10:11]
    v_pk_fma_f32 v[98:99], v[98:99], v[10:11], v[10:11]
    v_pk_fma_f32 v[100:101], v[100:101], v[10:11], v[10:11]
    v_pk_fma_f32 v[102:103], v[102:103], v[10:11], v[10:11]
    v_rcp_f32 v96, v96
    v_rcp_f32 v97, v97
    v_rcp_f32 v98, v98
    v_rcp_f32 v99, v99
    v_rcp_f32 v100, v100
    v_rcp_f32 v101, v101
    v_rcp_f32 v102, v102
    v_rcp_f32 v103, v103
    v_pk_mul_f32 v[104:105], v[96:97], v[104:105]
    v_pk_mul_f32 v[106:107], v[98:99], v[106:107]
    v_pk_mul_f32 v[108:109], v[100:101], v[108:109]
    v_pk_mul_f32 v[110:111], v[102:103], v[110:111]
    v_cvt_pk_bf16_f32 v40, v104, v105
    v_cvt_pk_bf16_f32 v41, v106, v107
    v_cvt_pk_bf16_f32 v42, v108, v109
    v_cvt_pk_bf16_f32 v43, v110, v111
    buffer_store_dwordx4 v[40:43], v22, s[16:19], s64 offen offset:1024 sc1
    v_pk_mul_f32 v[120:121], v[112:113], v[120:121]
    v_pk_mul_f32 v[112:113], v[112:113], v[12:13]
    v_pk_mul_f32 v[122:123], v[114:115], v[122:123]
    v_pk_mul_f32 v[114:115], v[114:115], v[12:13]
    v_pk_mul_f32 v[124:125], v[116:117], v[124:125]
    v_pk_mul_f32 v[116:117], v[116:117], v[12:13]
    v_pk_mul_f32 v[126:127], v[118:119], v[126:127]
    v_pk_mul_f32 v[118:119], v[118:119], v[12:13]
    v_exp_f32 v112, v112
    v_exp_f32 v113, v113
    v_exp_f32 v114, v114
    v_exp_f32 v115, v115
    v_exp_f32 v116, v116
    v_exp_f32 v117, v117
    v_exp_f32 v118, v118
    v_exp_f32 v119, v119
    v_pk_fma_f32 v[112:113], v[112:113], v[14:15], v[14:15]
    v_pk_fma_f32 v[114:115], v[114:115], v[14:15], v[14:15]
    v_pk_fma_f32 v[116:117], v[116:117], v[14:15], v[14:15]
    v_pk_fma_f32 v[118:119], v[118:119], v[14:15], v[14:15]
    v_rcp_f32 v112, v112
    v_rcp_f32 v113, v113
    v_rcp_f32 v114, v114
    v_rcp_f32 v115, v115
    v_rcp_f32 v116, v116
    v_rcp_f32 v117, v117
    v_rcp_f32 v118, v118
    v_rcp_f32 v119, v119
    v_pk_mul_f32 v[120:121], v[112:113], v[120:121]
    v_pk_mul_f32 v[122:123], v[114:115], v[122:123]
    v_pk_mul_f32 v[124:125], v[116:117], v[124:125]
    v_pk_mul_f32 v[126:127], v[118:119], v[126:127]
    v_cvt_pk_bf16_f32 v44, v120, v121
    v_cvt_pk_bf16_f32 v45, v122, v123
    v_cvt_pk_bf16_f32 v46, v124, v125
    v_cvt_pk_bf16_f32 v47, v126, v127
    buffer_store_dwordx4 v[44:47], v22, s[16:19], s65 offen offset:1024 sc1
    v_pk_mul_f32 v[136:137], v[128:129], v[136:137]
    v_pk_mul_f32 v[128:129], v[128:129], v[8:9]
    v_pk_mul_f32 v[138:139], v[130:131], v[138:139]
    v_pk_mul_f32 v[130:131], v[130:131], v[8:9]
    v_pk_mul_f32 v[140:141], v[132:133], v[140:141]
    v_pk_mul_f32 v[132:133], v[132:133], v[8:9]
    v_pk_mul_f32 v[142:143], v[134:135], v[142:143]
    v_pk_mul_f32 v[134:135], v[134:135], v[8:9]
    v_exp_f32 v128, v128
    v_exp_f32 v129, v129
    v_exp_f32 v130, v130
    v_exp_f32 v131, v131
    v_exp_f32 v132, v132
    v_exp_f32 v133, v133
    v_exp_f32 v134, v134
    v_exp_f32 v135, v135
    v_pk_fma_f32 v[128:129], v[128:129], v[10:11], v[10:11]
    v_pk_fma_f32 v[130:131], v[130:131], v[10:11], v[10:11]
    v_pk_fma_f32 v[132:133], v[132:133], v[10:11], v[10:11]
    v_pk_fma_f32 v[134:135], v[134:135], v[10:11], v[10:11]
    v_rcp_f32 v128, v128
    v_rcp_f32 v129, v129
    v_rcp_f32 v130, v130
    v_rcp_f32 v131, v131
    v_rcp_f32 v132, v132
    v_rcp_f32 v133, v133
    v_rcp_f32 v134, v134
    v_rcp_f32 v135, v135
    v_pk_mul_f32 v[136:137], v[128:129], v[136:137]
    v_pk_mul_f32 v[138:139], v[130:131], v[138:139]
    v_pk_mul_f32 v[140:141], v[132:133], v[140:141]
    v_pk_mul_f32 v[142:143], v[134:135], v[142:143]
    v_cvt_pk_bf16_f32 v48, v136, v137
    v_cvt_pk_bf16_f32 v49, v138, v139
    v_cvt_pk_bf16_f32 v50, v140, v141
    v_cvt_pk_bf16_f32 v51, v142, v143
    buffer_store_dwordx4 v[48:51], v22, s[16:19], s64 offen offset:2048 sc1
    v_pk_mul_f32 v[152:153], v[144:145], v[152:153]
    v_pk_mul_f32 v[144:145], v[144:145], v[12:13]
    v_pk_mul_f32 v[154:155], v[146:147], v[154:155]
    v_pk_mul_f32 v[146:147], v[146:147], v[12:13]
    v_pk_mul_f32 v[156:157], v[148:149], v[156:157]
    v_pk_mul_f32 v[148:149], v[148:149], v[12:13]
    v_pk_mul_f32 v[158:159], v[150:151], v[158:159]
    v_pk_mul_f32 v[150:151], v[150:151], v[12:13]
    v_exp_f32 v144, v144
    v_exp_f32 v145, v145
    v_exp_f32 v146, v146
    v_exp_f32 v147, v147
    v_exp_f32 v148, v148
    v_exp_f32 v149, v149
    v_exp_f32 v150, v150
    v_exp_f32 v151, v151
    v_pk_fma_f32 v[144:145], v[144:145], v[14:15], v[14:15]
    v_pk_fma_f32 v[146:147], v[146:147], v[14:15], v[14:15]
    v_pk_fma_f32 v[148:149], v[148:149], v[14:15], v[14:15]
    v_pk_fma_f32 v[150:151], v[150:151], v[14:15], v[14:15]
    v_rcp_f32 v144, v144
    v_rcp_f32 v145, v145
    v_rcp_f32 v146, v146
    v_rcp_f32 v147, v147
    v_rcp_f32 v148, v148
    v_rcp_f32 v149, v149
    v_rcp_f32 v150, v150
    v_rcp_f32 v151, v151
    v_pk_mul_f32 v[152:153], v[144:145], v[152:153]
    v_pk_mul_f32 v[154:155], v[146:147], v[154:155]
    v_pk_mul_f32 v[156:157], v[148:149], v[156:157]
    v_pk_mul_f32 v[158:159], v[150:151], v[158:159]
    v_cvt_pk_bf16_f32 v52, v152, v153
    v_cvt_pk_bf16_f32 v53, v154, v155
    v_cvt_pk_bf16_f32 v54, v156, v157
    v_cvt_pk_bf16_f32 v55, v158, v159
    buffer_store_dwordx4 v[52:55], v22, s[16:19], s65 offen offset:2048 sc1
    v_pk_mul_f32 v[168:169], v[160:161], v[168:169]
    v_pk_mul_f32 v[160:161], v[160:161], v[8:9]
    v_pk_mul_f32 v[170:171], v[162:163], v[170:171]
    v_pk_mul_f32 v[162:163], v[162:163], v[8:9]
    v_pk_mul_f32 v[172:173], v[164:165], v[172:173]
    v_pk_mul_f32 v[164:165], v[164:165], v[8:9]
    v_pk_mul_f32 v[174:175], v[166:167], v[174:175]
    v_pk_mul_f32 v[166:167], v[166:167], v[8:9]
    v_exp_f32 v160, v160
    v_exp_f32 v161, v161
    v_exp_f32 v162, v162
    v_exp_f32 v163, v163
    v_exp_f32 v164, v164
    v_exp_f32 v165, v165
    v_exp_f32 v166, v166
    v_exp_f32 v167, v167
    v_pk_fma_f32 v[160:161], v[160:161], v[10:11], v[10:11]
    v_pk_fma_f32 v[162:163], v[162:163], v[10:11], v[10:11]
    v_pk_fma_f32 v[164:165], v[164:165], v[10:11], v[10:11]
    v_pk_fma_f32 v[166:167], v[166:167], v[10:11], v[10:11]
    v_rcp_f32 v160, v160
    v_rcp_f32 v161, v161
    v_rcp_f32 v162, v162
    v_rcp_f32 v163, v163
    v_rcp_f32 v164, v164
    v_rcp_f32 v165, v165
    v_rcp_f32 v166, v166
    v_rcp_f32 v167, v167
    v_pk_mul_f32 v[168:169], v[160:161], v[168:169]
    v_pk_mul_f32 v[170:171], v[162:163], v[170:171]
    v_pk_mul_f32 v[172:173], v[164:165], v[172:173]
    v_pk_mul_f32 v[174:175], v[166:167], v[174:175]
    v_cvt_pk_bf16_f32 v56, v168, v169
    v_cvt_pk_bf16_f32 v57, v170, v171
    v_cvt_pk_bf16_f32 v58, v172, v173
    v_cvt_pk_bf16_f32 v59, v174, v175
    buffer_store_dwordx4 v[56:59], v22, s[16:19], s64 offen offset:3072 sc1
    s_waitcnt lgkmcnt(0)
    s_lshl_b32 s57, s44, 2
    s_add_u32 s57, s57, 163680
    v_mov_b32 v2, s57
    v_mov_b32 v3, 1
    s_mov_b64 exec, 1
    ds_write_b32 v2, v3
    s_mov_b64 exec, -1
    v_pk_mul_f32 v[184:185], v[176:177], v[184:185]
    v_pk_mul_f32 v[176:177], v[176:177], v[12:13]
    v_pk_mul_f32 v[186:187], v[178:179], v[186:187]
    v_pk_mul_f32 v[178:179], v[178:179], v[12:13]
    v_pk_mul_f32 v[188:189], v[180:181], v[188:189]
    v_pk_mul_f32 v[180:181], v[180:181], v[12:13]
    v_pk_mul_f32 v[190:191], v[182:183], v[190:191]
    v_pk_mul_f32 v[182:183], v[182:183], v[12:13]
    v_exp_f32 v176, v176
    v_exp_f32 v177, v177
    v_exp_f32 v178, v178
    v_exp_f32 v179, v179
    v_exp_f32 v180, v180
    v_exp_f32 v181, v181
    v_exp_f32 v182, v182
    v_exp_f32 v183, v183
    v_pk_fma_f32 v[176:177], v[176:177], v[14:15], v[14:15]
    v_pk_fma_f32 v[178:179], v[178:179], v[14:15], v[14:15]
    v_pk_fma_f32 v[180:181], v[180:181], v[14:15], v[14:15]
    v_pk_fma_f32 v[182:183], v[182:183], v[14:15], v[14:15]
    v_rcp_f32 v176, v176
    v_rcp_f32 v177, v177
    v_rcp_f32 v178, v178
    v_rcp_f32 v179, v179
    v_rcp_f32 v180, v180
    v_rcp_f32 v181, v181
    v_rcp_f32 v182, v182
    v_rcp_f32 v183, v183
    v_pk_mul_f32 v[184:185], v[176:177], v[184:185]
    v_pk_mul_f32 v[186:187], v[178:179], v[186:187]
    v_pk_mul_f32 v[188:189], v[180:181], v[188:189]
    v_pk_mul_f32 v[190:191], v[182:183], v[190:191]
    v_cvt_pk_bf16_f32 v60, v184, v185
    v_cvt_pk_bf16_f32 v61, v186, v187
    v_cvt_pk_bf16_f32 v62, v188, v189
    v_cvt_pk_bf16_f32 v63, v190, v191
    buffer_store_dwordx4 v[60:63], v22, s[16:19], s65 offen offset:3072 sc1
    s_setprio 0
    s_waitcnt lgkmcnt(0)
    v_mov_b32 v2, 163760
    ds_read_b64 v[2:3], v2
    s_waitcnt lgkmcnt(0)
    v_readfirstlane_b32 s78, v2
    v_readfirstlane_b32 s79, v3
    s_nop 3
    s_lshl_b32 s59, 1, s51
    v_lshlrev_b32 v2, 2, v1
    v_add_u32 v2, 163696, v2
    v_min_u32 v2, 163836, v2
    s_mov_b32 s67, 0
L_LW_19:
    ds_read_b32 v3, v2
    s_waitcnt lgkmcnt(0)
    v_cmp_le_u32 vcc, 1, v3
    s_nop 3
    s_and_b32 s57, vcc_lo, s59
    s_cmp_eq_u32 s57, s59
    s_cbranch_scc1 L_LO_20
    s_add_u32 s67, s67, 1
    s_cmp_lt_u32 s67, 800000
    s_cbranch_scc1 L_LW_19
L_LO_20:
    ds_read_b64_tr_b16 v[128:129], v25 offset:0
    ds_read_b64_tr_b16 v[130:131], v25 offset:1024
    ds_read_b64_tr_b16 v[132:133], v26 offset:0
    ds_read_b64_tr_b16 v[134:135], v26 offset:1024
    ds_read_b64_tr_b16 v[136:137], v25 offset:2048
    ds_read_b64_tr_b16 v[138:139], v25 offset:3072
    ds_read_b64_tr_b16 v[140:141], v26 offset:2048
    ds_read_b64_tr_b16 v[142:143], v26 offset:3072
    ds_read_b64_tr_b16 v[144:145], v25 offset:4096
    ds_read_b64_tr_b16 v[146:147], v25 offset:5120
    ds_read_b64_tr_b16 v[148:149], v26 offset:4096
    ds_read_b64_tr_b16 v[150:151], v26 offset:5120
    s_waitcnt lgkmcnt(8)
    s_add_u32 m0, s66, 0
    s_add_u32 s57, s71, 7168
    buffer_load_dwordx4 v24, s[12:15], s71 offen lds
    s_add_u32 m0, s66, 1024
    s_add_u32 s71, s71, 14336
    buffer_load_dwordx4 v24, s[12:15], s57 offen lds
    s_cmp_ge_u32 s71, 200704
    s_cselect_b32 s71, 0, s71
    s_waitcnt lgkmcnt(4)
    s_add_u32 m0, s66, 2048
    s_add_u32 s57, s71, 7168
    buffer_load_dwordx4 v24, s[12:15], s71 offen lds
    s_add_u32 m0, s66, 3072
    s_add_u32 s71, s71, 14336
    buffer_load_dwordx4 v24, s[12:15], s57 offen lds
    s_cmp_ge_u32 s71, 200704
    s_cselect_b32 s71, 0, s71
    s_waitcnt lgkmcnt(0)
    s_add_u32 m0, s66, 4096
    s_add_u32 s57, s71, 7168
    buffer_load_dwordx4 v24, s[12:15], s71 offen lds
    s_add_u32 m0, s66, 5120
    s_add_u32 s71, s71, 14336
    buffer_load_dwordx4 v24, s[12:15], s57 offen lds
    s_cmp_ge_u32 s71, 200704
    s_cselect_b32 s71, 0, s71
    v_lshlrev_b32 v2, 2, v1
    v_add_u32 v2, 163696, v2
    v_min_u32 v2, 163836, v2
    s_mov_b32 s67, 0
L_LW_21:
    ds_read_b32 v3, v2
    s_waitcnt lgkmcnt(0)
    v_cmp_le_u32 vcc, 2, v3
    s_nop 3
    s_and_b32 s57, vcc_lo, s59
    s_cmp_eq_u32 s57, s59
    s_cbranch_scc1 L_LO_22
    s_add_u32 s67, s67, 1
    s_cmp_lt_u32 s67, 800000
    s_cbranch_scc1 L_LW_21
L_LO_22:
    ds_read_b64_tr_b16 v[152:153], v25 offset:24576
    ds_read_b64_tr_b16 v[154:155], v25 offset:25600
    ds_read_b64_tr_b16 v[156:157], v26 offset:24576
    ds_read_b64_tr_b16 v[158:159], v26 offset:25600
    ds_read_b64_tr_b16 v[160:161], v25 offset:26624
    ds_read_b64_tr_b16 v[162:163], v25 offset:27648
    ds_read_b64_tr_b16 v[164:165], v26 offset:26624
    ds_read_b64_tr_b16 v[166:167], v26 offset:27648
    ds_read_b64_tr_b16 v[168:169], v25 offset:28672
    ds_read_b64_tr_b16 v[170:171], v25 offset:29696
    ds_read_b64_tr_b16 v[172:173], v26 offset:28672
    ds_read_b64_tr_b16 v[174:175], v26 offset:29696
    s_waitcnt lgkmcnt(8)
    s_add_u32 m0, s66, 24576
    s_add_u32 s57, s71, 7168
    buffer_load_dwordx4 v24, s[12:15], s71 offen lds
    s_add_u32 m0, s66, 25600
    s_add_u32 s71, s71, 14336
    buffer_load_dwordx4 v24, s[12:15], s57 offen lds
    s_cmp_ge_u32 s71, 200704
    s_cselect_b32 s71, 0, s71
    s_waitcnt lgkmcnt(4)
    s_add_u32 m0, s66, 26624
    s_add_u32 s57, s71, 7168
    buffer_load_dwordx4 v24, s[12:15], s71 offen lds
    s_add_u32 m0, s66, 27648
    s_add_u32 s71, s71, 14336
    buffer_load_dwordx4 v24, s[12:15], s57 offen lds
    s_cmp_ge_u32 s71, 200704
    s_cselect_b32 s71, 0, s71
    v_lshlrev_b32 v2, 2, v1
    v_add_u32 v2, 163696, v2
    v_min_u32 v2, 163836, v2
    s_mov_b32 s67, 0
L_LW_23:
    ds_read_b32 v3, v2
    s_waitcnt lgkmcnt(0)
    v_cmp_le_u32 vcc, 3, v3
    s_nop 3
    s_and_b32 s57, vcc_lo, s59
    s_cmp_eq_u32 s57, s59
    s_cbranch_scc1 L_LO_24
    s_add_u32 s67, s67, 1
    s_cmp_lt_u32 s67, 800000
    s_cbranch_scc1 L_LW_23
L_LO_24:
    ds_read_b64_tr_b16 v[176:177], v25 offset:49152
    ds_read_b64_tr_b16 v[178:179], v25 offset:50176
    ds_read_b64_tr_b16 v[180:181], v26 offset:49152
    ds_read_b64_tr_b16 v[182:183], v26 offset:50176
    ds_read_b64_tr_b16 v[184:185], v25 offset:51200
    ds_read_b64_tr_b16 v[186:187], v25 offset:52224
    ds_read_b64_tr_b16 v[188:189], v26 offset:51200
    ds_read_b64_tr_b16 v[190:191], v26 offset:52224
    ds_read_b64_tr_b16 v[192:193], v25 offset:53248
    ds_read_b64_tr_b16 v[194:195], v25 offset:54272
    ds_read_b64_tr_b16 v[196:197], v26 offset:53248
    ds_read_b64_tr_b16 v[198:199], v26 offset:54272
    s_waitcnt vmcnt(10)
    s_lshl_b32 s57, s45, 1
    s_add_u32 s57, s57, s50
    s_mul_i32 s57, s57, 14
    s_add_u32 s57, s57, s46
    s_lshl_b32 s57, s57, 8
    s_lshl_b32 s58, s51, 3
    s_add_u32 s57, s57, s58
    s_add_u32 s57, s57, 13631488
    v_mov_b32 v6, s78
    v_mov_b32 v7, s79
    v_mov_b32 v8, 0
    s_mov_b64 exec, 1
    buffer_store_dwordx2 v[6:7], v8, s[16:19], s57 offen sc1
    s_mov_b64 exec, -1
    s_lshr_b32 s52, s44, 2
    s_lshl_b32 s52, s52, 1
    s_add_u32 s52, s52, s50
    v_and_b32 v2, 15, v1
    v_lshrrev_b32 v3, 4, v1
    v_add_u32 v4, 1, v2
    v_and_b32 v5, 3, v4
    v_and_b32 v4, 28, v4
    v_mul_u32_u24 v5, 4160, v5
    v_lshl_add_u32 v5, v4, 1, v5
    v_lshl_add_u32 v5, v3, 4, v5
    s_mul_i32 s57, s53, 16640
    s_lshl_b32 s58, s52, 7
    s_add_u32 s57, s57, s58
    s_add_u32 s57, s57, 98304
    v_add_u32 v27, s57, v5
    s_mul_i32 s59, s53, 4608
    s_add_u32 s57, s59, s58
    s_add_u32 s57, s57, 132064
    v_lshlrev_b32 v4, 4, v3
    v_lshlrev_b32 v5, 5, v2
    v_sub_u32 v4, v4, v5
    v_add_u32 v28, s57, v4
    s_lshl_b32 s57, s53, 15
    s_lshl_b32 s58, s52, 11
    s_add_u32 s57, s57, s58
    v_add_u32 v30, s57, v22
    s_mov_b32 s58, 0x3
    v_lshlrev_b32 v2, 2, v1
    v_add_u32 v2, 163632, v2
    v_min_u32 v2, 163836, v2
    s_mov_b32 s67, 0
L_LW_25:
    ds_read_b32 v3, v2
    s_waitcnt lgkmcnt(0)
    v_cmp_le_u32 vcc, 1, v3
    s_nop 3
    s_and_b32 s57, vcc_lo, s58
    s_cmp_eq_u32 s57, s58
    s_cbranch_scc1 L_LO_26
    s_add_u32 s67, s67, 1
    s_cmp_lt_u32 s67, 800000
    s_cbranch_scc1 L_LW_25
L_LO_26:
    ds_read_b64 v[32:33], v27 offset:0
    ds_read_b64 v[34:35], v27 offset:8
    ds_read_b128 v[36:39], v28 offset:3584
    ds_read_b64 v[40:41], v27 offset:512
    ds_read_b64 v[42:43], v27 offset:520
    ds_read_b128 v[44:47], v28 offset:3072
    ds_read_b64 v[48:49], v27 offset:1024
    ds_read_b64 v[50:51], v27 offset:1032
    ds_read_b128 v[52:55], v28 offset:2560
    ds_read_b64 v[56:57], v27 offset:1536
    ds_read_b64 v[58:59], v27 offset:1544
    ds_read_b128 v[60:63], v28 offset:2048
    s_waitcnt lgkmcnt(9)
    v_mfma_f32_16x16x32_bf16 v[64:67], v[32:35], v[36:39], 0
    s_waitcnt lgkmcnt(7)
    v_mfma_f32_16x16x32_bf16 v[68:71], v[40:43], v[36:39], 0
    s_waitcnt lgkmcnt(6)
    v_mfma_f32_16x16x32_bf16 v[72:75], v[40:43], v[44:47], 0
    v_mfma_f32_16x16x32_bf16 v[68:71], v[32:35], v[44:47], v[68:71]
    ds_read_b64 v[96:97], v27 offset:2048
    ds_read_b64 v[98:99], v27 offset:2056
    s_waitcnt lgkmcnt(6)
    v_mfma_f32_16x16x32_bf16 v[72:75], v[48:51], v[36:39], v[72:75]
    v_mfma_f32_16x16x32_bf16 v[76:79], v[48:51], v[44:47], 0
    s_waitcnt lgkmcnt(5)
    v_mfma_f32_16x16x32_bf16 v[80:83], v[48:51], v[52:55], 0
    v_mfma_f32_16x16x32_bf16 v[72:75], v[32:35], v[52:55], v[72:75]
    ds_read_b128 v[100:103], v28 offset:1536
    v_mfma_f32_16x16x32_bf16 v[76:79], v[40:43], v[52:55], v[76:79]
    s_waitcnt lgkmcnt(4)
    v_mfma_f32_16x16x32_bf16 v[76:79], v[56:59], v[36:39], v[76:79]
    v_mfma_f32_16x16x32_bf16 v[80:83], v[56:59], v[44:47], v[80:83]
    v_mfma_f32_16x16x32_bf16 v[84:87], v[56:59], v[52:55], 0
    ds_read_b64 v[104:105], v27 offset:2560
    ds_read_b64 v[106:107], v27 offset:2568
    s_waitcnt lgkmcnt(5)
    v_mfma_f32_16x16x32_bf16 v[88:91], v[56:59], v[60:63], 0
    v_mfma_f32_16x16x32_bf16 v[76:79], v[32:35], v[60:63], v[76:79]
    v_mfma_f32_16x16x32_bf16 v[80:83], v[40:43], v[60:63], v[80:83]
    ds_read_b128 v[108:111], v28 offset:1024
    v_mfma_f32_16x16x32_bf16 v[84:87], v[48:51], v[60:63], v[84:87]
    s_waitcnt lgkmcnt(4)
    v_mfma_f32_16x16x32_bf16 v[80:83], v[96:99], v[36:39], v[80:83]
    v_mfma_f32_16x16x32_bf16 v[84:87], v[96:99], v[44:47], v[84:87]
    ds_read_b64 v[112:113], v27 offset:3072
    ds_read_b64 v[114:115], v27 offset:3080
    v_mfma_f32_16x16x32_bf16 v[88:91], v[96:99], v[52:55], v[88:91]
    v_mfma_f32_16x16x32_bf16 v[92:95], v[96:99], v[60:63], 0
    ds_read_b128 v[116:119], v28 offset:512
    s_waitcnt lgkmcnt(6)
    v_mfma_f32_16x16x32_bf16 v[80:83], v[32:35], v[100:103], v[80:83]
    v_mfma_f32_16x16x32_bf16 v[84:87], v[40:43], v[100:103], v[84:87]
    ds_read_b64 v[120:121], v27 offset:3584
    ds_read_b64 v[122:123], v27 offset:3592
    v_mfma_f32_16x16x32_bf16 v[88:91], v[48:51], v[100:103], v[88:91]
    ds_read_b128 v[124:127], v28 offset:0
    v_mfma_f32_16x16x32_bf16 v[92:95], v[56:59], v[100:103], v[92:95]
    ds_read_b64 v[240:241], v27 offset:64
    ds_read_b64 v[242:243], v27 offset:72
    ds_read_b128 v[244:247], v28 offset:3648
    s_waitcnt lgkmcnt(10)
    v_mfma_f32_16x16x32_bf16 v[84:87], v[104:107], v[36:39], v[84:87]
    ds_read_b64 v[248:249], v27 offset:576
    ds_read_b64 v[250:251], v27 offset:584
    v_mfma_f32_16x16x32_bf16 v[88:91], v[104:107], v[44:47], v[88:91]
    ds_read_b128 v[96:99], v28 offset:3136
    v_mfma_f32_16x16x32_bf16 v[92:95], v[104:107], v[52:55], v[92:95]
    s_waitcnt lgkmcnt(12)
    v_mfma_f32_16x16x32_bf16 v[84:87], v[32:35], v[108:111], v[84:87]
    ds_read_b64 v[60:61], v27 offset:1088
    ds_read_b64 v[62:63], v27 offset:1096
    v_mfma_f32_16x16x32_bf16 v[88:91], v[40:43], v[108:111], v[88:91]
    v_mfma_f32_16x16x32_bf16 v[92:95], v[48:51], v[108:111], v[92:95]
    s_waitcnt lgkmcnt(12)
    v_mfma_f32_16x16x32_bf16 v[88:91], v[112:115], v[36:39], v[88:91]
    ds_read_b128 v[56:59], v28 offset:2624
    v_mfma_f32_16x16x32_bf16 v[92:95], v[112:115], v[44:47], v[92:95]
    s_waitcnt lgkmcnt(12)
    v_mfma_f32_16x16x32_bf16 v[88:91], v[32:35], v[116:119], v[88:91]
    ds_read_b64 v[100:101], v27 offset:1600
    ds_read_b64 v[102:103], v27 offset:1608
    v_mfma_f32_16x16x32_bf16 v[92:95], v[40:43], v[116:119], v[92:95]
    s_waitcnt lgkmcnt(12)
    v_mfma_f32_16x16x32_bf16 v[92:95], v[120:123], v[36:39], v[92:95]
    s_waitcnt lgkmcnt(11)
    v_mfma_f32_16x16x32_bf16 v[92:95], v[32:35], v[124:127], v[92:95]
    ds_read_b128 v[104:107], v28 offset:2112
    s_waitcnt lgkmcnt(9)
    v_mfma_f32_16x16x32_bf16 v[64:67], v[240:243], v[244:247], v[64:67]
    s_waitcnt vmcnt(9)
    ds_read_b64_tr_b16 v[200:201], v25 offset:0
    ds_read_b64_tr_b16 v[202:203], v25 offset:1024
    ds_read_b64_tr_b16 v[204:205], v26 offset:0
    ds_read_b64_tr_b16 v[206:207], v26 offset:1024
    s_waitcnt lgkmcnt(11)
    v_mfma_f32_16x16x32_bf16 v[68:71], v[248:251], v[244:247], v[68:71]
    s_waitcnt lgkmcnt(10)
    v_mfma_f32_16x16x32_bf16 v[72:75], v[248:251], v[96:99], v[72:75]
    v_mfma_f32_16x16x32_bf16 v[68:71], v[240:243], v[96:99], v[68:71]
    s_waitcnt vmcnt(7)
    ds_read_b64_tr_b16 v[208:209], v25 offset:2048
    ds_read_b64_tr_b16 v[210:211], v25 offset:3072
    ds_read_b64_tr_b16 v[212:213], v26 offset:2048
    ds_read_b64_tr_b16 v[214:215], v26 offset:3072
    s_waitcnt lgkmcnt(12)
    v_mfma_f32_16x16x32_bf16 v[72:75], v[60:63], v[244:247], v[72:75]
    ds_read_b64 v[52:53], v27 offset:2112
    ds_read_b64 v[54:55], v27 offset:2120
    v_mfma_f32_16x16x32_bf16 v[76:79], v[60:63], v[96:99], v[76:79]
    s_waitcnt lgkmcnt(13)
    v_mfma_f32_16x16x32_bf16 v[80:83], v[60:63], v[56:59], v[80:83]
    v_mfma_f32_16x16x32_bf16 v[72:75], v[240:243], v[56:59], v[72:75]
    v_mfma_f32_16x16x32_bf16 v[76:79], v[248:251], v[56:59], v[76:79]
    s_waitcnt lgkmcnt(0)
    s_waitcnt vmcnt(5)
    ds_read_b64_tr_b16 v[216:217], v25 offset:4096
    ds_read_b64_tr_b16 v[218:219], v25 offset:5120
    ds_read_b64_tr_b16 v[220:221], v26 offset:4096
    ds_read_b64_tr_b16 v[222:223], v26 offset:5120
    s_waitcnt vmcnt(3)
    ds_read_b64_tr_b16 v[224:225], v25 offset:24576
    ds_read_b64_tr_b16 v[226:227], v25 offset:25600
    ds_read_b64_tr_b16 v[228:229], v26 offset:24576
    ds_read_b64_tr_b16 v[230:231], v26 offset:25600
    s_waitcnt vmcnt(1)
    ds_read_b64_tr_b16 v[232:233], v25 offset:26624
    ds_read_b64_tr_b16 v[234:235], v25 offset:27648
    ds_read_b64_tr_b16 v[236:237], v26 offset:26624
    ds_read_b64_tr_b16 v[238:239], v26 offset:27648
    s_waitcnt lgkmcnt(0)
    s_barrier
    ds_read_b128 v[48:51], v28 offset:1600
    v_mfma_f32_16x16x32_bf16 v[76:79], v[100:103], v[244:247], v[76:79]
    ds_write_b128 v30, v[64:67] offset:0
    v_mfma_f32_16x16x32_bf16 v[80:83], v[100:103], v[96:99], v[80:83]
    v_mfma_f32_16x16x32_bf16 v[84:87], v[100:103], v[56:59], v[84:87]
    ds_write_b128 v30, v[68:71] offset:1024
    ds_read_b64 v[108:109], v27 offset:2624
    ds_read_b64 v[110:111], v27 offset:2632
    v_mfma_f32_16x16x32_bf16 v[88:91], v[100:103], v[104:107], v[88:91]
    v_mfma_f32_16x16x32_bf16 v[76:79], v[240:243], v[104:107], v[76:79]
    v_mfma_f32_16x16x32_bf16 v[80:83], v[248:251], v[104:107], v[80:83]
    ds_read_b128 v[112:115], v28 offset:1088
    v_mfma_f32_16x16x32_bf16 v[84:87], v[60:63], v[104:107], v[84:87]
    ds_write_b128 v30, v[72:75] offset:8192
    v_mfma_f32_16x16x32_bf16 v[80:83], v[52:55], v[244:247], v[80:83]
    v_mfma_f32_16x16x32_bf16 v[84:87], v[52:55], v[96:99], v[84:87]
    ds_read_b64 v[44:45], v27 offset:3136
    ds_read_b64 v[46:47], v27 offset:3144
    v_mfma_f32_16x16x32_bf16 v[88:91], v[52:55], v[56:59], v[88:91]
    v_mfma_f32_16x16x32_bf16 v[92:95], v[52:55], v[104:107], v[92:95]
    ds_read_b128 v[40:43], v28 offset:576
    s_waitcnt lgkmcnt(9)
    v_mfma_f32_16x16x32_bf16 v[80:83], v[240:243], v[48:51], v[80:83]
    v_mfma_f32_16x16x32_bf16 v[84:87], v[248:251], v[48:51], v[84:87]
    ds_write_b128 v30, v[76:79] offset:9216
    ds_read_b64 v[116:117], v27 offset:3648
    ds_read_b64 v[118:119], v27 offset:3656
    v_mfma_f32_16x16x32_bf16 v[88:91], v[60:63], v[48:51], v[88:91]
    v_lshlrev_b32 v29, 8, v1
    s_mul_i32 s60, s47, 3584
    s_add_u32 s60, s60, 13631488
    s_mov_b64 exec, 0x3fff
    buffer_load_dwordx4 v[8:11], v29, s[16:19], s60 offen sc1
    s_mov_b64 exec, -1
    ds_read_b128 v[120:123], v28 offset:64
    v_mfma_f32_16x16x32_bf16 v[92:95], v[100:103], v[48:51], v[92:95]
    s_waitcnt lgkmcnt(9)
    v_mfma_f32_16x16x32_bf16 v[84:87], v[108:111], v[244:247], v[84:87]
    v_mfma_f32_16x16x32_bf16 v[88:91], v[108:111], v[96:99], v[88:91]
    v_mfma_f32_16x16x32_bf16 v[92:95], v[108:111], v[56:59], v[92:95]
    s_waitcnt lgkmcnt(8)
    v_mfma_f32_16x16x32_bf16 v[84:87], v[240:243], v[112:115], v[84:87]
    v_mfma_f32_16x16x32_bf16 v[88:91], v[248:251], v[112:115], v[88:91]
    ds_write_b128 v30, v[80:83] offset:16384
    v_mfma_f32_16x16x32_bf16 v[92:95], v[60:63], v[112:115], v[92:95]
    s_waitcnt lgkmcnt(6)
    v_mfma_f32_16x16x32_bf16 v[88:91], v[44:47], v[244:247], v[88:91]
    v_mfma_f32_16x16x32_bf16 v[92:95], v[44:47], v[96:99], v[92:95]
    s_waitcnt lgkmcnt(5)
    v_mfma_f32_16x16x32_bf16 v[88:91], v[240:243], v[40:43], v[88:91]
    v_mfma_f32_16x16x32_bf16 v[92:95], v[248:251], v[40:43], v[92:95]
    s_waitcnt lgkmcnt(2)
    v_mfma_f32_16x16x32_bf16 v[92:95], v[116:119], v[244:247], v[92:95]
    s_waitcnt lgkmcnt(1)
    v_mfma_f32_16x16x32_bf16 v[92:95], v[240:243], v[120:123], v[92:95]
    ds_write_b128 v30, v[84:87] offset:17408
    s_nop 7
    ds_write_b128 v30, v[88:91] offset:24576
    ds_write_b128 v30, v[92:95] offset:25600
L_G2:
    s_mul_i32 s57, s44, 224
    s_lshr_b32 s58, s57, 7
    s_add_u32 s57, s57, 223
    s_lshr_b32 s57, s57, 7
    s_sub_u32 s57, s57, s58
    s_add_u32 s57, s57, 1
    s_bfm_b32 s65, s57, s58
    s_waitcnt vmcnt(0)
    v_cmp_eq_u64 vcc, s[78:79], v[8:9]
    v_cmp_eq_u64 s[62:63], s[78:79], v[10:11]
    s_nop 3
    s_and_b32 s57, vcc_lo, s62
    s_and_b32 s57, s57, s65
    s_cmp_eq_u32 s57, s65
    s_cselect_b32 s77, 1, 0
    s_cbranch_scc0 L_NE_27
    s_add_u32 s57, s68, s72
    buffer_load_dwordx4 v[32:35], v22, s[16:19], s57 offen sc1
    s_add_u32 s72, s72, 1024
    s_cmp_ge_u32 s72, 14336
    s_cselect_b32 s72, 0, s72
    s_add_u32 s57, s68, s72
    buffer_load_dwordx4 v[36:39], v22, s[16:19], s57 offen sc1
    s_add_u32 s72, s72, 1024
    s_cmp_ge_u32 s72, 14336
    s_cselect_b32 s72, 0, s72
    s_add_u32 s57, s68, s72
    buffer_load_dwordx4 v[40:43], v22, s[16:19], s57 offen sc1
    s_add_u32 s72, s72, 1024
    s_cmp_ge_u32 s72, 14336
    s_cselect_b32 s72, 0, s72
    s_add_u32 s57, s68, s72
    buffer_load_dwordx4 v[44:47], v22, s[16:19], s57 offen sc1
    s_add_u32 s72, s72, 1024
    s_cmp_ge_u32 s72, 14336
    s_cselect_b32 s72, 0, s72
    s_add_u32 s57, s68, s72
    buffer_load_dwordx4 v[48:51], v22, s[16:19], s57 offen sc1
    s_add_u32 s72, s72, 1024
    s_cmp_ge_u32 s72, 14336
    s_cselect_b32 s72, 0, s72
    s_add_u32 s57, s68, s72
    buffer_load_dwordx4 v[52:55], v22, s[16:19], s57 offen sc1
    s_add_u32 s72, s72, 1024
    s_cmp_ge_u32 s72, 14336
    s_cselect_b32 s72, 0, s72
    s_add_u32 s57, s68, s72
    buffer_load_dwordx4 v[56:59], v22, s[16:19], s57 offen sc1
    s_add_u32 s72, s72, 1024
    s_cmp_ge_u32 s72, 14336
    s_cselect_b32 s72, 0, s72
    s_add_u32 s57, s68, s72
    buffer_load_dwordx4 v[60:63], v22, s[16:19], s57 offen sc1
    s_add_u32 s72, s72, 1024
    s_cmp_ge_u32 s72, 14336
    s_cselect_b32 s72, 0, s72
    s_add_u32 s57, s68, s72
    buffer_load_dwordx4 v[240:243], v22, s[16:19], s57 offen sc1
    s_add_u32 s72, s72, 1024
    s_cmp_ge_u32 s72, 14336
    s_cselect_b32 s72, 0, s72
    s_add_u32 s57, s68, s72
    buffer_load_dwordx4 v[244:247], v22, s[16:19], s57 offen sc1
    s_add_u32 s72, s72, 1024
    s_cmp_ge_u32 s72, 14336
    s_cselect_b32 s72, 0, s72
    s_add_u32 s57, s68, s72
    buffer_load_dwordx4 v[248:251], v22, s[16:19], s57 offen sc1
    s_add_u32 s72, s72, 1024
    s_cmp_ge_u32 s72, 14336
    s_cselect_b32 s72, 0, s72
    s_branch L_NE_27_J
L_NE_27:
    s_mov_b64 exec, 0x3fff
    buffer_load_dwordx4 v[8:11], v29, s[16:19], s60 offen sc1
    s_mov_b64 exec, -1
L_NE_27_J:
    s_lshl_b32 s57, s53, 15
    s_lshl_b32 s58, s52, 13
    s_add_u32 s57, s57, s58
    v_add_u32 v2, s57, v22
    v_and_b32 v4, 15, v1
    v_lshrrev_b32 v5, 4, v1
    v_lshlrev_b32 v4, 5, v4
    v_lshl_add_u32 v4, v5, 3, v4
    s_mul_i32 s58, s53, 4608
    s_lshl_b32 s59, s52, 10
    s_sub_u32 s58, s58, s59
    s_add_u32 s58, s58, 135160
    v_sub_u32 v5, s58, v4
    ds_read_b64 v[12:13], v5 offset:512
    ds_read_b64 v[14:15], v5 offset:0
    s_lshl_b32 s57, s70, 1
    s_add_u32 s57, s57, s53
    s_lshl_b32 s58, s57, 13
    s_lshl_b32 s59, s52, 11
    s_add_u32 s58, s58, s59
    s_add_u32 s58, s58, 16777216
    s_waitcnt lgkmcnt(0)
    s_barrier
    ds_read_b128 v[96:99], v2 offset:0
    ds_read_b128 v[100:103], v2 offset:1024
    ds_read_b128 v[104:107], v2 offset:2048
    ds_read_b128 v[108:111], v2 offset:3072
    ds_read_b128 v[112:115], v2 offset:4096
    ds_read_b128 v[116:119], v2 offset:5120
    ds_read_b128 v[120:123], v2 offset:6144
    ds_read_b128 v[124:127], v2 offset:7168
    s_mov_b32 s64, s58
    s_cmp_eq_u32 s77, 1
    s_cbranch_scc1 L_DN_28
    s_waitcnt vmcnt(0)
    v_cmp_eq_u64 vcc, s[78:79], v[8:9]
    v_cmp_eq_u64 s[62:63], s[78:79], v[10:11]
    s_nop 3
    s_and_b32 s57, vcc_lo, s62
    s_and_b32 s57, s57, s65
    s_cmp_eq_u32 s57, s65
    s_cbranch_scc1 L_OK_29
    s_mov_b32 s67, 0
L_SPIN_30:
    s_sleep 1
    s_mov_b64 exec, 0x3fff
    buffer_load_dwordx4 v[8:11], v29, s[16:19], s60 offen sc1
    s_mov_b64 exec, -1
    s_waitcnt vmcnt(0)
    v_cmp_eq_u64 vcc, s[78:79], v[8:9]
    v_cmp_eq_u64 s[62:63], s[78:79], v[10:11]
    s_nop 3
    s_and_b32 s57, vcc_lo, s62
    s_and_b32 s57, s57, s65
    s_cmp_eq_u32 s57, s65
    s_cbranch_scc1 L_OK_29
    s_add_u32 s67, s67, 1
    s_cmp_lt_u32 s67, 200000
    s_cbranch_scc1 L_SPIN_30
L_OK_29:
    s_add_u32 s57, s68, s72
    buffer_load_dwordx4 v[32:35], v22, s[16:19], s57 offen sc1
    s_add_u32 s72, s72, 1024
    s_cmp_ge_u32 s72, 14336
    s_cselect_b32 s72, 0, s72
    s_add_u32 s57, s68, s72
    buffer_load_dwordx4 v[36:39], v22, s[16:19], s57 offen sc1
    s_add_u32 s72, s72, 1024
    s_cmp_ge_u32 s72, 14336
    s_cselect_b32 s72, 0, s72
    s_add_u32 s57, s68, s72
    buffer_load_dwordx4 v[40:43], v22, s[16:19], s57 offen sc1
    s_add_u32 s72, s72, 1024
    s_cmp_ge_u32 s72, 14336
    s_cselect_b32 s72, 0, s72
    s_add_u32 s57, s68, s72
    buffer_load_dwordx4 v[44:47], v22, s[16:19], s57 offen sc1
    s_add_u32 s72, s72, 1024
    s_cmp_ge_u32 s72, 14336
    s_cselect_b32 s72, 0, s72
    s_add_u32 s57, s68, s72
    buffer_load_dwordx4 v[48:51], v22, s[16:19], s57 offen sc1
    s_add_u32 s72, s72, 1024
    s_cmp_ge_u32 s72, 14336
    s_cselect_b32 s72, 0, s72
    s_add_u32 s57, s68, s72
    buffer_load_dwordx4 v[52:55], v22, s[16:19], s57 offen sc1
    s_add_u32 s72, s72, 1024
    s_cmp_ge_u32 s72, 14336
    s_cselect_b32 s72, 0, s72
    s_add_u32 s57, s68, s72
    buffer_load_dwordx4 v[56:59], v22, s[16:19], s57 offen sc1
    s_add_u32 s72, s72, 1024
    s_cmp_ge_u32 s72, 14336
    s_cselect_b32 s72, 0, s72
    s_add_u32 s57, s68, s72
    buffer_load_dwordx4 v[60:63], v22, s[16:19], s57 offen sc1
    s_add_u32 s72, s72, 1024
    s_cmp_ge_u32 s72, 14336
    s_cselect_b32 s72, 0, s72
    s_add_u32 s57, s68, s72
    buffer_load_dwordx4 v[240:243], v22, s[16:19], s57 offen sc1
    s_add_u32 s72, s72, 1024
    s_cmp_ge_u32 s72, 14336
    s_cselect_b32 s72, 0, s72
    s_add_u32 s57, s68, s72
    buffer_load_dwordx4 v[244:247], v22, s[16:19], s57 offen sc1
    s_add_u32 s72, s72, 1024
    s_cmp_ge_u32 s72, 14336
    s_cselect_b32 s72, 0, s72
    s_add_u32 s57, s68, s72
    buffer_load_dwordx4 v[248:251], v22, s[16:19], s57 offen sc1
    s_add_u32 s72, s72, 1024
    s_cmp_ge_u32 s72, 14336
    s_cselect_b32 s72, 0, s72
L_DN_28:
    s_waitcnt lgkmcnt(0)
    v_add_f32 v96, v96, v104
    v_add_f32 v112, v112, v120
    v_add_f32 v97, v97, v105
    v_add_f32 v113, v113, v121
    v_add_f32 v98, v98, v106
    v_add_f32 v114, v114, v122
    v_add_f32 v99, v99, v107
    v_add_f32 v115, v115, v123
    v_add_f32 v100, v100, v108
    v_add_f32 v116, v116, v124
    v_add_f32 v101, v101, v109
    v_add_f32 v117, v117, v125
    v_add_f32 v102, v102, v110
    v_add_f32 v118, v118, v126
    v_add_f32 v103, v103, v111
    v_add_f32 v119, v119, v127
    v_add_f32 v96, v96, v112
    v_add_f32 v97, v97, v113
    v_add_f32 v98, v98, v114
    v_add_f32 v99, v99, v115
    v_add_f32 v100, v100, v116
    v_add_f32 v101, v101, v117
    v_add_f32 v102, v102, v118
    v_add_f32 v103, v103, v119
    v_and_b32 v104, 0xffff0000, v13
    v_lshlrev_b32 v105, 16, v13
    v_and_b32 v106, 0xffff0000, v12
    v_lshlrev_b32 v107, 16, v12
    v_and_b32 v108, 0xffff0000, v15
    v_lshlrev_b32 v109, 16, v15
    v_and_b32 v110, 0xffff0000, v14
    v_lshlrev_b32 v111, 16, v14
    s_waitcnt vmcnt(10)
    v_mfma_f32_32x32x16_bf16 v[64:79], v[128:131], v[32:35], 0
    v_mfma_f32_32x32x16_bf16 v[80:95], v[132:135], v[32:35], 0
    s_add_u32 s57, s68, s72
    buffer_load_dwordx4 v[32:35], v22, s[16:19], s57 offen sc1
    s_add_u32 s72, s72, 1024
    s_cmp_ge_u32 s72, 14336
    s_cselect_b32 s72, 0, s72
    v_mul_f32 v104, s61, v104
    v_mul_f32 v105, s61, v105
    v_mul_f32 v106, s61, v106
    v_mul_f32 v107, s61, v107
    v_mul_f32 v108, s61, v108
    v_mul_f32 v109, s61, v109
    v_mul_f32 v110, s61, v110
    v_mul_f32 v111, s61, v111
    v_cvt_pk_bf16_f32 v96, 0, v96
    v_cvt_pk_bf16_f32 v97, 0, v97
    v_cvt_pk_bf16_f32 v98, 0, v98
    v_cvt_pk_bf16_f32 v99, 0, v99
    v_cvt_pk_bf16_f32 v100, 0, v100
    v_cvt_pk_bf16_f32 v101, 0, v101
    v_cvt_pk_bf16_f32 v102, 0, v102
    v_cvt_pk_bf16_f32 v103, 0, v103
    s_waitcnt vmcnt(10)
    v_mfma_f32_32x32x16_bf16 v[64:79], v[136:139], v[36:39], v[64:79]
    v_mfma_f32_32x32x16_bf16 v[80:95], v[140:143], v[36:39], v[80:95]
    s_add_u32 s57, s68, s72
    buffer_load_dwordx4 v[36:39], v22, s[16:19], s57 offen sc1
    s_add_u32 s72, s72, 1024
    s_cmp_ge_u32 s72, 14336
    s_cselect_b32 s72, 0, s72
    v_cvt_pk_bf16_f32 v104, 0, v104
    v_cvt_pk_bf16_f32 v105, 0, v105
    v_cvt_pk_bf16_f32 v106, 0, v106
    v_cvt_pk_bf16_f32 v107, 0, v107
    v_cvt_pk_bf16_f32 v108, 0, v108
    v_cvt_pk_bf16_f32 v109, 0, v109
    v_cvt_pk_bf16_f32 v110, 0, v110
    v_cvt_pk_bf16_f32 v111, 0, v111
    v_add_f32 v96, v96, v104
    v_add_f32 v97, v97, v105
    v_add_f32 v98, v98, v106
    v_add_f32 v99, v99, v107
    v_add_f32 v100, v100, v108
    v_add_f32 v101, v101, v109
    v_add_f32 v102, v102, v110
    v_add_f32 v103, v103, v111
    s_waitcnt vmcnt(10)
    v_mfma_f32_32x32x16_bf16 v[64:79], v[144:147], v[40:43], v[64:79]
    v_mfma_f32_32x32x16_bf16 v[80:95], v[148:151], v[40:43], v[80:95]
    s_add_u32 s57, s68, s72
    buffer_load_dwordx4 v[40:43], v22, s[16:19], s57 offen sc1
    s_add_u32 s72, s72, 1024
    s_cmp_ge_u32 s72, 14336
    s_cselect_b32 s72, 0, s72
    v_cvt_pk_bf16_f32 v112, v96, v97
    v_cvt_pk_bf16_f32 v113, v98, v99
    v_mov_b32 v114, s78
    v_mov_b32 v115, s79
    buffer_store_dwordx4 v[112:115], v22, s[16:19], s64 offen offset:0 sc1
    v_cvt_pk_bf16_f32 v116, v100, v101
    v_cvt_pk_bf16_f32 v117, v102, v103
    v_mov_b32 v118, s78
    v_mov_b32 v119, s79
    buffer_store_dwordx4 v[116:119], v22, s[16:19], s64 offen offset:1024 sc1
    s_waitcnt lgkmcnt(0)
    s_lshl_b32 s57, s44, 2
    s_add_u32 s57, s57, 163712
    v_mov_b32 v2, s57
    v_mov_b32 v3, 1
    s_mov_b64 exec, 1
    ds_write_b32 v2, v3
    s_mov_b64 exec, -1
    s_waitcnt vmcnt(12)
    v_mfma_f32_32x32x16_bf16 v[64:79], v[152:155], v[44:47], v[64:79]
    v_mfma_f32_32x32x16_bf16 v[80:95], v[156:159], v[44:47], v[80:95]
    s_add_u32 s57, s69, s72
    buffer_load_dwordx4 v[44:47], v22, s[16:19], s57 offen sc1
    s_add_u32 s72, s72, 1024
    s_cmp_ge_u32 s72, 14336
    s_cselect_b32 s72, 0, s72
    s_waitcnt vmcnt(12)
    v_mfma_f32_32x32x16_bf16 v[64:79], v[160:163], v[48:51], v[64:79]
    v_mfma_f32_32x32x16_bf16 v[80:95], v[164:167], v[48:51], v[80:95]
    s_add_u32 s57, s69, s72
    buffer_load_dwordx4 v[48:51], v22, s[16:19], s57 offen sc1
    s_add_u32 s72, s72, 1024
    s_cmp_ge_u32 s72, 14336
    s_cselect_b32 s72, 0, s72
    s_waitcnt vmcnt(12)
    v_mfma_f32_32x32x16_bf16 v[64:79], v[168:171], v[52:55], v[64:79]
    v_mfma_f32_32x32x16_bf16 v[80:95], v[172:175], v[52:55], v[80:95]
    s_add_u32 s57, s69, s72
    buffer_load_dwordx4 v[52:55], v22, s[16:19], s57 offen sc1
    s_add_u32 s72, s72, 1024
    s_cmp_ge_u32 s72, 14336
    s_cselect_b32 s72, 0, s72
    s_waitcnt vmcnt(12)
    v_mfma_f32_32x32x16_bf16 v[64:79], v[176:179], v[56:59], v[64:79]
    v_mfma_f32_32x32x16_bf16 v[80:95], v[180:183], v[56:59], v[80:95]
    s_add_u32 s57, s69, s72
    buffer_load_dwordx4 v[56:59], v22, s[16:19], s57 offen sc1
    s_add_u32 s72, s72, 1024
    s_cmp_ge_u32 s72, 14336
    s_cselect_b32 s72, 0, s72
    v_lshrrev_b32 v2, 3, v0
    v_and_b32 v3, 7, v0
    s_lshl_b32 s57, s47, 6
    v_add_u32 v4, s57, v2
    v_mul_u32_u24 v5, 896, v4
    v_lshl_add_u32 v5, v3, 4, v5
    s_lshl_b32 s57, s48, 7
    v_add_u32 v16, s57, v5
    v_lshlrev_b32 v4, 4, v4
    s_mov_b32 s57, 12582912
    buffer_load_dwordx4 v[8:11], v16, s[4:7], 0 offen
    buffer_load_dwordx4 v[12:15], v4, s[16:19], s57 offen sc1
    s_waitcnt vmcnt(14)
    v_mfma_f32_32x32x16_bf16 v[64:79], v[184:187], v[60:63], v[64:79]
    v_mfma_f32_32x32x16_bf16 v[80:95], v[188:191], v[60:63], v[80:95]
    s_add_u32 s57, s69, s72
    buffer_load_dwordx4 v[60:63], v22, s[16:19], s57 offen sc1
    s_add_u32 s72, s72, 1024
    s_cmp_ge_u32 s72, 14336
    s_cselect_b32 s72, 0, s72
    s_waitcnt vmcnt(14)
    v_mfma_f32_32x32x16_bf16 v[64:79], v[192:195], v[240:243], v[64:79]
    v_mfma_f32_32x32x16_bf16 v[80:95], v[196:199], v[240:243], v[80:95]
    s_add_u32 s57, s69, s72
    buffer_load_dwordx4 v[240:243], v22, s[16:19], s57 offen sc1
    s_add_u32 s72, s72, 1024
    s_cmp_ge_u32 s72, 14336
    s_cselect_b32 s72, 0, s72
    s_waitcnt vmcnt(14)
    v_mfma_f32_32x32x16_bf16 v[64:79], v[200:203], v[244:247], v[64:79]
    v_mfma_f32_32x32x16_bf16 v[80:95], v[204:207], v[244:247], v[80:95]
    s_add_u32 s57, s69, s72
    buffer_load_dwordx4 v[244:247], v22, s[16:19], s57 offen sc1
    s_add_u32 s72, s72, 1024
    s_cmp_ge_u32 s72, 14336
    s_cselect_b32 s72, 0, s72
    s_waitcnt vmcnt(14)
    v_mfma_f32_32x32x16_bf16 v[64:79], v[208:211], v[248:251], v[64:79]
    v_mfma_f32_32x32x16_bf16 v[80:95], v[212:215], v[248:251], v[80:95]
    s_add_u32 s57, s69, s72
    buffer_load_dwordx4 v[248:251], v22, s[16:19], s57 offen sc1
    s_add_u32 s72, s72, 1024
    s_cmp_ge_u32 s72, 14336
    s_cselect_b32 s72, 0, s72
    s_waitcnt vmcnt(14)
    v_mfma_f32_32x32x16_bf16 v[64:79], v[216:219], v[32:35], v[64:79]
    v_mfma_f32_32x32x16_bf16 v[80:95], v[220:223], v[32:35], v[80:95]
    s_add_u32 s57, s69, s72
    buffer_load_dwordx4 v[32:35], v22, s[16:19], s57 offen sc1
    s_add_u32 s72, s72, 1024
    s_cmp_ge_u32 s72, 14336
    s_cselect_b32 s72, 0, s72
    s_waitcnt vmcnt(14)
    v_mfma_f32_32x32x16_bf16 v[64:79], v[224:227], v[36:39], v[64:79]
    v_mfma_f32_32x32x16_bf16 v[80:95], v[228:231], v[36:39], v[80:95]
    s_add_u32 s57, s69, s72
    buffer_load_dwordx4 v[36:39], v22, s[16:19], s57 offen sc1
    s_add_u32 s72, s72, 1024
    s_cmp_ge_u32 s72, 14336
    s_cselect_b32 s72, 0, s72
    s_waitcnt vmcnt(14)
    v_mfma_f32_32x32x16_bf16 v[64:79], v[232:235], v[40:43], v[64:79]
    v_mfma_f32_32x32x16_bf16 v[80:95], v[236:239], v[40:43], v[80:95]
    s_add_u32 s57, s69, s72
    buffer_load_dwordx4 v[40:43], v22, s[16:19], s57 offen sc1
    s_add_u32 s72, s72, 1024
    s_cmp_ge_u32 s72, 14336
    s_cselect_b32 s72, 0, s72
    s_waitcnt vmcnt(12)
    v_mfma_f32_32x32x16_bf16 v[96:111], v[128:131], v[44:47], 0
    v_mfma_f32_32x32x16_bf16 v[112:127], v[132:135], v[44:47], 0
    s_add_u32 s57, s69, s72
    buffer_load_dwordx4 v[44:47], v22, s[16:19], s57 offen sc1
    s_add_u32 s72, s72, 1024
    s_cmp_ge_u32 s72, 14336
    s_cselect_b32 s72, 0, s72
    s_add_u32 s57, s69, s72
    buffer_load_dwordx4 v[128:131], v22, s[16:19], s57 offen sc1
    s_add_u32 s72, s72, 1024
    s_cmp_ge_u32 s72, 14336
    s_cselect_b32 s72, 0, s72
    s_add_u32 s57, s69, s72
    buffer_load_dwordx4 v[132:135], v22, s[16:19], s57 offen sc1
    s_add_u32 s72, s72, 1024
    s_cmp_ge_u32 s72, 14336
    s_cselect_b32 s72, 0, s72
    s_waitcnt vmcnt(14)
    v_mfma_f32_32x32x16_bf16 v[96:111], v[136:139], v[48:51], v[96:111]
    v_mfma_f32_32x32x16_bf16 v[112:127], v[140:143], v[48:51], v[112:127]
    s_mov_b32 s58, 0xff
    v_lshlrev_b32 v2, 2, v1
    v_add_u32 v2, 163712, v2
    v_min_u32 v2, 163836, v2
    s_mov_b32 s67, 0
L_LW_31:
    ds_read_b32 v3, v2
    s_waitcnt lgkmcnt(0)
    v_cmp_le_u32 vcc, 1, v3
    s_nop 3
    s_and_b32 s57, vcc_lo, s58
    s_cmp_eq_u32 s57, s58
    s_cbranch_scc1 L_LO_32
    s_add_u32 s67, s67, 1
    s_cmp_lt_u32 s67, 800000
    s_cbranch_scc1 L_LW_31
L_LO_32:
    v_and_b32 v5, 31, v1
    v_lshrrev_b32 v6, 5, v1
    v_and_b32 v7, 15, v1
    v_xor_b32 v6, v6, v7
    v_lshlrev_b32 v6, 4, v6
    v_lshl_add_u32 v6, v5, 8, v6
    s_add_u32 s57, s44, 2
    s_and_b32 s57, s57, 7
    s_lshl_b32 s57, s57, 14
    v_add_u32 v17, s57, v6
    v_xor_b32 v18, 32, v17
    v_xor_b32 v19, 64, v17
    v_xor_b32 v20, 96, v17
    v_xor_b32 v21, 128, v17
    v_xor_b32 v24, 160, v17
    v_xor_b32 v25, 192, v17
    v_xor_b32 v26, 224, v17
    s_waitcnt vmcnt(13)
    v_mfma_f32_32x32x16_bf16 v[96:111], v[144:147], v[52:55], v[96:111]
    v_mfma_f32_32x32x16_bf16 v[112:127], v[148:151], v[52:55], v[112:127]
    ds_write_b128 v17, v[64:67]
    s_waitcnt vmcnt(12)
    v_mfma_f32_32x32x16_bf16 v[96:111], v[152:155], v[56:59], v[96:111]
    v_mfma_f32_32x32x16_bf16 v[112:127], v[156:159], v[56:59], v[112:127]
    ds_write_b128 v18, v[68:71]
    s_waitcnt vmcnt(9)
    v_mfma_f32_32x32x16_bf16 v[96:111], v[160:163], v[60:63], v[96:111]
    v_mfma_f32_32x32x16_bf16 v[112:127], v[164:167], v[60:63], v[112:127]
    ds_write_b128 v19, v[72:75]
    s_waitcnt vmcnt(8)
    v_mfma_f32_32x32x16_bf16 v[96:111], v[168:171], v[240:243], v[96:111]
    v_mfma_f32_32x32x16_bf16 v[112:127], v[172:175], v[240:243], v[112:127]
    ds_write_b128 v20, v[76:79]
    s_waitcnt vmcnt(7)
    v_mfma_f32_32x32x16_bf16 v[96:111], v[176:179], v[244:247], v[96:111]
    v_mfma_f32_32x32x16_bf16 v[112:127], v[180:183], v[244:247], v[112:127]
    ds_write_b128 v21, v[80:83]
    s_waitcnt vmcnt(6)
    v_mfma_f32_32x32x16_bf16 v[96:111], v[184:187], v[248:251], v[96:111]
    v_mfma_f32_32x32x16_bf16 v[112:127], v[188:191], v[248:251], v[112:127]
    ds_write_b128 v24, v[84:87]
    s_waitcnt vmcnt(5)
    v_mfma_f32_32x32x16_bf16 v[96:111], v[192:195], v[32:35], v[96:111]
    v_mfma_f32_32x32x16_bf16 v[112:127], v[196:199], v[32:35], v[112:127]
    ds_write_b128 v25, v[88:91]
    s_waitcnt vmcnt(4)
    v_mfma_f32_32x32x16_bf16 v[96:111], v[200:203], v[36:39], v[96:111]
    v_mfma_f32_32x32x16_bf16 v[112:127], v[204:207], v[36:39], v[112:127]
    ds_write_b128 v26, v[92:95]
    s_waitcnt vmcnt(3)
    v_mfma_f32_32x32x16_bf16 v[96:111], v[208:211], v[40:43], v[96:111]
    v_mfma_f32_32x32x16_bf16 v[112:127], v[212:215], v[40:43], v[112:127]
    v_lshrrev_b32 v4, 4, v1
    v_bfe_u32 v5, v1, 2, 2
    v_and_b32 v6, 3, v1
    v_lshlrev_b32 v7, 13, v4
    v_lshl_add_u32 v7, v5, 8, v7
    v_lshl_add_u32 v7, v6, 4, v7
    s_lshl_b32 s60, s48, 19
    s_lshl_b32 s58, s44, 16
    s_add_u32 s60, s60, s58
    s_lshr_b32 s58, s47, 2
    s_lshl_b32 s58, s58, 10
    s_add_u32 s60, s60, s58
    s_and_b32 s58, s47, 3
    s_lshl_b32 s58, s58, 6
    s_add_u32 s60, s60, s58
    s_add_u32 s60, s60, 16777216
    s_add_u32 s57, s60, 0
    buffer_load_dwordx4 v[136:139], v7, s[16:19], s57 offen sc1
    s_add_u32 s57, s60, 32768
    buffer_load_dwordx4 v[140:143], v7, s[16:19], s57 offen sc1
    s_waitcnt vmcnt(4)
    v_mfma_f32_32x32x16_bf16 v[96:111], v[216:219], v[44:47], v[96:111]
    v_mfma_f32_32x32x16_bf16 v[112:127], v[220:223], v[44:47], v[112:127]
    s_waitcnt vmcnt(3)
    v_mfma_f32_32x32x16_bf16 v[96:111], v[224:227], v[128:131], v[96:111]
    v_mfma_f32_32x32x16_bf16 v[112:127], v[228:231], v[128:131], v[112:127]
    s_waitcnt vmcnt(2)
    v_mfma_f32_32x32x16_bf16 v[96:111], v[232:235], v[132:135], v[96:111]
    v_mfma_f32_32x32x16_bf16 v[112:127], v[236:239], v[132:135], v[112:127]
    v_lshrrev_b32 v3, 1, v5
    v_lshl_add_u32 v3, v6, 1, v3
    v_xor_b32 v3, s44, v3
    v_lshlrev_b32 v3, 4, v3
    v_lshl_add_u32 v3, v6, 11, v3
    v_lshl_add_u32 v3, v5, 9, v3
    v_lshl_add_u32 v3, v4, 1, v3
    v_add_u32 v3, 131584, v3
    s_nop 4
    ds_write_b128 v17, v[96:99] offset:8192
    ds_write_b128 v18, v[100:103] offset:8192
    ds_write_b128 v19, v[104:107] offset:8192
    ds_write_b128 v20, v[108:111] offset:8192
    ds_write_b128 v21, v[112:115] offset:8192
    ds_write_b128 v24, v[116:119] offset:8192
    ds_write_b128 v25, v[120:123] offset:8192
    ds_write_b128 v26, v[124:127] offset:8192
    s_waitcnt vmcnt(0)
    v_cmp_eq_u64 vcc, s[78:79], v[138:139]
    v_cmp_eq_u64 s[62:63], s[78:79], v[142:143]
    s_nop 3
    s_and_b64 s[62:63], vcc, s[62:63]
    s_cmp_eq_u64 s[62:63], -1
    s_cbranch_scc1 L_OK_33
    s_mov_b32 s67, 0
L_SPIN_34:
    s_sleep 2
    s_add_u32 s57, s60, 0
    buffer_load_dwordx4 v[136:139], v7, s[16:19], s57 offen sc1
    s_add_u32 s57, s60, 32768
    buffer_load_dwordx4 v[140:143], v7, s[16:19], s57 offen sc1
    s_waitcnt vmcnt(0)
    v_cmp_eq_u64 vcc, s[78:79], v[138:139]
    v_cmp_eq_u64 s[62:63], s[78:79], v[142:143]
    s_nop 3
    s_and_b64 s[62:63], vcc, s[62:63]
    s_cmp_eq_u64 s[62:63], -1
    s_cbranch_scc1 L_OK_33
    s_add_u32 s67, s67, 1
    s_cmp_lt_u32 s67, 200000
    s_cbranch_scc1 L_SPIN_34
L_OK_33:
    ds_write_b16 v3, v136 offset:0
    ds_write_b16_d16_hi v3, v136 offset:128
    ds_write_b16 v3, v137 offset:256
    ds_write_b16_d16_hi v3, v137 offset:384
    ds_write_b16 v3, v140 offset:8
    ds_write_b16_d16_hi v3, v140 offset:136
    ds_write_b16 v3, v141 offset:264
    ds_write_b16_d16_hi v3, v141 offset:392
    s_waitcnt lgkmcnt(0)
    s_barrier
    v_and_b32 v3, 7, v0
    v_lshrrev_b32 v2, 3, v0
    v_and_b32 v5, 15, v2
    v_lshlrev_b32 v6, 1, v3
    v_xor_b32 v6, v6, v5
    v_lshlrev_b32 v6, 4, v6
    v_lshl_add_u32 v6, v2, 8, v6
    v_xor_b32 v7, 16, v6
    v_add_u32 v29, 0x10000, v6
    v_add_u32 v30, 0x10000, v7
    ds_read_b128 v[64:67], v6 offset:0
    ds_read_b128 v[68:71], v7 offset:0
    ds_read_b128 v[72:75], v6 offset:16384
    ds_read_b128 v[76:79], v7 offset:16384
    ds_read_b128 v[80:83], v6 offset:32768
    ds_read_b128 v[84:87], v7 offset:32768
    ds_read_b128 v[88:91], v6 offset:49152
    ds_read_b128 v[92:95], v7 offset:49152
    ds_read_b128 v[96:99], v29 offset:0
    ds_read_b128 v[100:103], v30 offset:0
    ds_read_b128 v[104:107], v29 offset:16384
    ds_read_b128 v[108:111], v30 offset:16384
    s_waitcnt lgkmcnt(8)
    v_add_f32 v64, v64, v72
    v_add_f32 v65, v65, v73
    v_add_f32 v66, v66, v74
    v_add_f32 v67, v67, v75
    v_add_f32 v68, v68, v76
    v_add_f32 v69, v69, v77
    v_add_f32 v70, v70, v78
    v_add_f32 v71, v71, v79
    ds_read_b128 v[112:115], v29 offset:32768
    ds_read_b128 v[116:119], v30 offset:32768
    ds_read_b128 v[120:123], v29 offset:49152
    ds_read_b128 v[124:127], v30 offset:49152
    v_lshrrev_b32 v5, 3, v2
    v_xor_b32 v5, v5, v3
    v_lshlrev_b32 v5, 4, v5
    v_lshl_add_u32 v5, v2, 7, v5
    v_add_u32 v5, 131584, v5
    s_waitcnt lgkmcnt(8)
    ds_read_b128 v[240:243], v5
    v_add_f32 v80, v80, v88
    v_add_f32 v81, v81, v89
    v_add_f32 v82, v82, v90
    v_add_f32 v83, v83, v91
    v_add_f32 v84, v84, v92
    v_add_f32 v85, v85, v93
    v_add_f32 v86, v86, v94
    v_add_f32 v87, v87, v95
    s_waitcnt lgkmcnt(5)
    v_add_f32 v96, v96, v104
    v_add_f32 v97, v97, v105
    v_add_f32 v98, v98, v106
    v_add_f32 v99, v99, v107
    v_add_f32 v100, v100, v108
    v_add_f32 v101, v101, v109
    v_add_f32 v102, v102, v110
    v_add_f32 v103, v103, v111
    v_add_f32 v64, v64, v80
    v_add_f32 v65, v65, v81
    v_add_f32 v66, v66, v82
    v_add_f32 v67, v67, v83
    v_add_f32 v68, v68, v84
    v_add_f32 v69, v69, v85
    v_add_f32 v70, v70, v86
    v_add_f32 v71, v71, v87
    s_waitcnt lgkmcnt(1)
    v_add_f32 v112, v112, v120
    v_add_f32 v113, v113, v121
    v_add_f32 v114, v114, v122
    v_add_f32 v115, v115, v123
    v_add_f32 v116, v116, v124
    v_add_f32 v117, v117, v125
    v_add_f32 v118, v118, v126
    v_add_f32 v119, v119, v127
    v_add_f32 v96, v96, v112
    v_add_f32 v97, v97, v113
    v_add_f32 v98, v98, v114
    v_add_f32 v99, v99, v115
    v_add_f32 v100, v100, v116
    v_add_f32 v101, v101, v117
    v_add_f32 v102, v102, v118
    v_add_f32 v103, v103, v119
    v_add_f32 v64, v64, v96
    v_add_f32 v65, v65, v97
    v_add_f32 v66, v66, v98
    v_add_f32 v67, v67, v99
    v_add_f32 v68, v68, v100
    v_add_f32 v69, v69, v101
    v_add_f32 v70, v70, v102
    v_add_f32 v71, v71, v103
    v_cvt_pk_bf16_f32 v64, 0, v64
    v_cvt_pk_bf16_f32 v65, 0, v65
    v_cvt_pk_bf16_f32 v66, 0, v66
    v_cvt_pk_bf16_f32 v67, 0, v67
    v_cvt_pk_bf16_f32 v68, 0, v68
    v_cvt_pk_bf16_f32 v69, 0, v69
    v_cvt_pk_bf16_f32 v70, 0, v70
    v_cvt_pk_bf16_f32 v71, 0, v71
    v_mul_f32 v72, 0xbfb8aa3b, v64
    v_mul_f32 v73, 0xbfb8aa3b, v65
    v_mul_f32 v74, 0xbfb8aa3b, v66
    v_mul_f32 v75, 0xbfb8aa3b, v67
    v_mul_f32 v76, 0xbfb8aa3b, v68
    v_mul_f32 v77, 0xbfb8aa3b, v69
    v_mul_f32 v78, 0xbfb8aa3b, v70
    v_mul_f32 v79, 0xbfb8aa3b, v71
    v_exp_f32 v72, v72
    v_exp_f32 v73, v73
    v_exp_f32 v74, v74
    v_exp_f32 v75, v75
    v_exp_f32 v76, v76
    v_exp_f32 v77, v77
    v_exp_f32 v78, v78
    v_exp_f32 v79, v79
    s_waitcnt lgkmcnt(0)
    v_lshlrev_b32 v80, 16, v8
    v_lshlrev_b32 v88, 16, v240
    v_and_b32 v81, 0xffff0000, v8
    v_and_b32 v89, 0xffff0000, v240
    v_lshlrev_b32 v82, 16, v9
    v_lshlrev_b32 v90, 16, v241
    v_and_b32 v83, 0xffff0000, v9
    v_and_b32 v91, 0xffff0000, v241
    v_lshlrev_b32 v84, 16, v10
    v_lshlrev_b32 v92, 16, v242
    v_and_b32 v85, 0xffff0000, v10
    v_and_b32 v93, 0xffff0000, v242
    v_lshlrev_b32 v86, 16, v11
    v_lshlrev_b32 v94, 16, v243
    v_and_b32 v87, 0xffff0000, v11
    v_and_b32 v95, 0xffff0000, v243
    v_lshlrev_b32 v12, 16, v12
    v_add_f32 v72, 1.0, v72
    v_add_f32 v96, v80, v12
    v_add_f32 v73, 1.0, v73
    v_add_f32 v97, v81, v12
    v_add_f32 v74, 1.0, v74
    v_add_f32 v98, v82, v12
    v_add_f32 v75, 1.0, v75
    v_add_f32 v99, v83, v12
    v_add_f32 v76, 1.0, v76
    v_add_f32 v100, v84, v12
    v_add_f32 v77, 1.0, v77
    v_add_f32 v101, v85, v12
    v_add_f32 v78, 1.0, v78
    v_add_f32 v102, v86, v12
    v_add_f32 v79, 1.0, v79
    v_add_f32 v103, v87, v12
    v_rcp_f32 v72, v72
    v_rcp_f32 v73, v73
    v_rcp_f32 v74, v74
    v_rcp_f32 v75, v75
    v_rcp_f32 v76, v76
    v_rcp_f32 v77, v77
    v_rcp_f32 v78, v78
    v_rcp_f32 v79, v79
    v_cvt_pk_bf16_f32 v96, 0, v96
    v_cvt_pk_bf16_f32 v97, 0, v97
    v_cvt_pk_bf16_f32 v98, 0, v98
    v_cvt_pk_bf16_f32 v99, 0, v99
    v_cvt_pk_bf16_f32 v100, 0, v100
    v_cvt_pk_bf16_f32 v101, 0, v101
    v_cvt_pk_bf16_f32 v102, 0, v102
    v_cvt_pk_bf16_f32 v103, 0, v103
    v_mul_f32 v96, v96, v15
    v_mul_f32 v64, v64, v72
    v_mul_f32 v97, v97, v15
    v_mul_f32 v65, v65, v73
    v_mul_f32 v98, v98, v15
    v_mul_f32 v66, v66, v74
    v_mul_f32 v99, v99, v15
    v_mul_f32 v67, v67, v75
    v_mul_f32 v100, v100, v15
    v_mul_f32 v68, v68, v76
    v_mul_f32 v101, v101, v15
    v_mul_f32 v69, v69, v77
    v_mul_f32 v102, v102, v15
    v_mul_f32 v70, v70, v78
    v_mul_f32 v103, v103, v15
    v_mul_f32 v71, v71, v79
    v_cvt_pk_bf16_f32 v96, 0, v96
    v_cvt_pk_bf16_f32 v64, 0, v64
    v_cvt_pk_bf16_f32 v97, 0, v97
    v_cvt_pk_bf16_f32 v65, 0, v65
    v_cvt_pk_bf16_f32 v98, 0, v98
    v_cvt_pk_bf16_f32 v66, 0, v66
    v_cvt_pk_bf16_f32 v99, 0, v99
    v_cvt_pk_bf16_f32 v67, 0, v67
    v_cvt_pk_bf16_f32 v100, 0, v100
    v_cvt_pk_bf16_f32 v68, 0, v68
    v_cvt_pk_bf16_f32 v101, 0, v101
    v_cvt_pk_bf16_f32 v69, 0, v69
    v_cvt_pk_bf16_f32 v102, 0, v102
    v_cvt_pk_bf16_f32 v70, 0, v70
    v_cvt_pk_bf16_f32 v103, 0, v103
    v_cvt_pk_bf16_f32 v71, 0, v71
    v_mul_f32 v96, v96, v88
    v_mul_f32 v97, v97, v89
    v_mul_f32 v98, v98, v90
    v_mul_f32 v99, v99, v91
    v_mul_f32 v100, v100, v92
    v_mul_f32 v101, v101, v93
    v_mul_f32 v102, v102, v94
    v_mul_f32 v103, v103, v95
    v_cvt_pk_bf16_f32 v96, 0, v96
    v_cvt_pk_bf16_f32 v97, 0, v97
    v_cvt_pk_bf16_f32 v98, 0, v98
    v_cvt_pk_bf16_f32 v99, 0, v99
    v_cvt_pk_bf16_f32 v100, 0, v100
    v_cvt_pk_bf16_f32 v101, 0, v101
    v_cvt_pk_bf16_f32 v102, 0, v102
    v_cvt_pk_bf16_f32 v103, 0, v103
    v_mul_f32 v96, v96, v64
    v_mul_f32 v97, v97, v65
    v_mul_f32 v98, v98, v66
    v_mul_f32 v99, v99, v67
    v_mul_f32 v100, v100, v68
    v_mul_f32 v101, v101, v69
    v_mul_f32 v102, v102, v70
    v_mul_f32 v103, v103, v71
    v_cvt_pk_bf16_f32 v96, 0, v96
    v_cvt_pk_bf16_f32 v97, 0, v97
    v_cvt_pk_bf16_f32 v98, 0, v98
    v_cvt_pk_bf16_f32 v99, 0, v99
    v_cvt_pk_bf16_f32 v100, 0, v100
    v_cvt_pk_bf16_f32 v101, 0, v101
    v_cvt_pk_bf16_f32 v102, 0, v102
    v_cvt_pk_bf16_f32 v103, 0, v103
    v_add_f32 v96, v96, v80
    v_add_f32 v97, v97, v81
    v_add_f32 v98, v98, v82
    v_add_f32 v99, v99, v83
    v_add_f32 v100, v100, v84
    v_add_f32 v101, v101, v85
    v_add_f32 v102, v102, v86
    v_add_f32 v103, v103, v87
    v_cvt_pk_bf16_f32 v64, v96, v97
    v_cvt_pk_bf16_f32 v65, v98, v99
    v_cvt_pk_bf16_f32 v66, v100, v101
    v_cvt_pk_bf16_f32 v67, v102, v103
    buffer_store_dwordx4 v[64:67], v16, s[20:23], 0 offen sc1
    s_branch L_END
L_SERVICE:
    s_mov_b32 s54, 0x3f803f80
    s_waitcnt lgkmcnt(0)
    s_mov_b32 s16, s88
    s_and_b32 s17, s89, 0xffff
    s_mov_b32 s18, 25165824
    s_mov_b32 s19, 0x20000
    s_mov_b32 s24, s86
    s_and_b32 s25, s87, 0xffff
    s_mov_b32 s26, 256
    s_mov_b32 s27, 0x20000
    s_mov_b32 s4, s64
    s_and_b32 s5, s65, 0xffff
    s_mov_b32 s6, 1835008
    s_mov_b32 s7, 0x20000
    s_cmp_lt_u32 s2, 16
    s_cselect_b32 s8, s78, s80
    s_cselect_b32 s9, s79, s81
    s_and_b32 s9, s9, 0xffff
    s_mov_b32 s10, 1605632
    s_mov_b32 s11, 0x20000
    s_or_b32 s57, s2, s44
    s_cmp_lg_u32 s57, 0
    s_cbranch_scc1 L_SA
    s_memrealtime s[62:63]
    s_waitcnt lgkmcnt(0)
    s_or_b32 s63, s63, 0x80000000
    v_mov_b32 v10, s62
    v_mov_b32 v11, s63
    v_mov_b32 v12, 0
    s_mov_b64 exec, 1
    buffer_store_dwordx2 v[10:11], v12, s[24:27], 0 offen sc1
    s_mov_b64 exec, -1
L_SA:
    v_lshrrev_b32 v2, 3, v0
    v_and_b32 v3, 7, v0
    s_lshl_b32 s57, s2, 6
    v_add_u32 v4, s57, v2
    v_mul_u32_u24 v4, 896, v4
    v_lshl_add_u32 v4, v3, 4, v4
    buffer_load_dwordx4 v[16:19], v4, s[4:7], 0 offen offset:0
    buffer_load_dwordx4 v[20:23], v4, s[4:7], 0 offen offset:128
    buffer_load_dwordx4 v[24:27], v4, s[4:7], 0 offen offset:256
    buffer_load_dwordx4 v[28:31], v4, s[4:7], 0 offen offset:384
    buffer_load_dwordx4 v[32:35], v4, s[4:7], 0 offen offset:512
    buffer_load_dwordx4 v[36:39], v4, s[4:7], 0 offen offset:640
    buffer_load_dwordx4 v[40:43], v4, s[4:7], 0 offen offset:768
    v_and_b32 v5, 15, v0
    v_lshrrev_b32 v6, 4, v0
    v_mul_u32_u24 v6, 3584, v6
    v_lshl_add_u32 v6, v5, 4, v6
    s_and_b32 s57, s2, 15
    s_mul_i32 s57, s57, 224
    v_add_u32 v6, s57, v6
    v_cmp_gt_u32 vcc, 14, v5
    v_mov_b32 v7, 0x7000000
    s_nop 0
    v_cndmask_b32 v6, v7, v6, vcc
    s_mov_b32 s57, 0
    buffer_load_dwordx4 v[44:47], v6, s[8:11], s57 offen
    s_mov_b32 s57, 114688
    buffer_load_dwordx4 v[48:51], v6, s[8:11], s57 offen
    s_mov_b32 s57, 229376
    buffer_load_dwordx4 v[52:55], v6, s[8:11], s57 offen
    s_mov_b32 s57, 344064
    buffer_load_dwordx4 v[56:59], v6, s[8:11], s57 offen
    s_mov_b32 s57, 458752
    buffer_load_dwordx4 v[60:63], v6, s[8:11], s57 offen
    s_mov_b32 s57, 573440
    buffer_load_dwordx4 v[64:67], v6, s[8:11], s57 offen
    s_mov_b32 s57, 688128
    buffer_load_dwordx4 v[68:71], v6, s[8:11], s57 offen
    s_mov_b32 s57, 802816
    buffer_load_dwordx4 v[72:75], v6, s[8:11], s57 offen
    s_mov_b32 s57, 917504
    buffer_load_dwordx4 v[76:79], v6, s[8:11], s57 offen
    s_mov_b32 s57, 1032192
    buffer_load_dwordx4 v[80:83], v6, s[8:11], s57 offen
    s_mov_b32 s57, 1146880
    buffer_load_dwordx4 v[84:87], v6, s[8:11], s57 offen
    s_mov_b32 s57, 1261568
    buffer_load_dwordx4 v[88:91], v6, s[8:11], s57 offen
    s_mov_b32 s57, 1376256
    buffer_load_dwordx4 v[92:95], v6, s[8:11], s57 offen
    s_mov_b32 s57, 1490944
    buffer_load_dwordx4 v[96:99], v6, s[8:11], s57 offen
    s_waitcnt vmcnt(14)
    v_mov_b32 v224, 0
    v_mov_b32 v225, 0
    v_mov_b32 v226, 0
    v_mov_b32 v227, 0
    v_dot2c_f32_bf16 v224, s54, v16
    v_dot2c_f32_bf16 v225, v16, v16
    v_dot2c_f32_bf16 v226, s54, v17
    v_dot2c_f32_bf16 v227, v17, v17
    v_dot2c_f32_bf16 v224, s54, v18
    v_dot2c_f32_bf16 v225, v18, v18
    v_dot2c_f32_bf16 v226, s54, v19
    v_dot2c_f32_bf16 v227, v19, v19
    v_dot2c_f32_bf16 v224, s54, v20
    v_dot2c_f32_bf16 v225, v20, v20
    v_dot2c_f32_bf16 v226, s54, v21
    v_dot2c_f32_bf16 v227, v21, v21
    v_dot2c_f32_bf16 v224, s54, v22
    v_dot2c_f32_bf16 v225, v22, v22
    v_dot2c_f32_bf16 v226, s54, v23
    v_dot2c_f32_bf16 v227, v23, v23
    v_dot2c_f32_bf16 v224, s54, v24
    v_dot2c_f32_bf16 v225, v24, v24
    v_dot2c_f32_bf16 v226, s54, v25
    v_dot2c_f32_bf16 v227, v25, v25
    v_dot2c_f32_bf16 v224, s54, v26
    v_dot2c_f32_bf16 v225, v26, v26
    v_dot2c_f32_bf16 v226, s54, v27
    v_dot2c_f32_bf16 v227, v27, v27
    v_dot2c_f32_bf16 v224, s54, v28
    v_dot2c_f32_bf16 v225, v28, v28
    v_dot2c_f32_bf16 v226, s54, v29
    v_dot2c_f32_bf16 v227, v29, v29
    v_dot2c_f32_bf16 v224, s54, v30
    v_dot2c_f32_bf16 v225, v30, v30
    v_dot2c_f32_bf16 v226, s54, v31
    v_dot2c_f32_bf16 v227, v31, v31
    v_dot2c_f32_bf16 v224, s54, v32
    v_dot2c_f32_bf16 v225, v32, v32
    v_dot2c_f32_bf16 v226, s54, v33
    v_dot2c_f32_bf16 v227, v33, v33
    v_dot2c_f32_bf16 v224, s54, v34
    v_dot2c_f32_bf16 v225, v34, v34
    v_dot2c_f32_bf16 v226, s54, v35
    v_dot2c_f32_bf16 v227, v35, v35
    v_dot2c_f32_bf16 v224, s54, v36
    v_dot2c_f32_bf16 v225, v36, v36
    v_dot2c_f32_bf16 v226, s54, v37
    v_dot2c_f32_bf16 v227, v37, v37
    v_dot2c_f32_bf16 v224, s54, v38
    v_dot2c_f32_bf16 v225, v38, v38
    v_dot2c_f32_bf16 v226, s54, v39
    v_dot2c_f32_bf16 v227, v39, v39
    v_dot2c_f32_bf16 v224, s54, v40
    v_dot2c_f32_bf16 v225, v40, v40
    v_dot2c_f32_bf16 v226, s54, v41
    v_dot2c_f32_bf16 v227, v41, v41
    v_dot2c_f32_bf16 v224, s54, v42
    v_dot2c_f32_bf16 v225, v42, v42
    v_dot2c_f32_bf16 v226, s54, v43
    v_dot2c_f32_bf16 v227, v43, v43
    s_nop 2
    v_add_f32 v224, v224, v226
    v_add_f32 v225, v225, v227
    s_nop 1
    v_add_f32_dpp v224, v224, v224 quad_perm:[1,0,3,2] row_mask:0xf bank_mask:0xf
    v_add_f32_dpp v225, v225, v225 quad_perm:[1,0,3,2] row_mask:0xf bank_mask:0xf
    s_nop 1
    v_add_f32_dpp v224, v224, v224 quad_perm:[2,3,0,1] row_mask:0xf bank_mask:0xf
    v_add_f32_dpp v225, v225, v225 quad_perm:[2,3,0,1] row_mask:0xf bank_mask:0xf
    s_nop 1
    v_add_f32_dpp v224, v224, v224 row_half_mirror row_mask:0xf bank_mask:0xf
    v_add_f32_dpp v225, v225, v225 row_half_mirror row_mask:0xf bank_mask:0xf
    s_nop 1
    v_mul_f32 v224, 0x3b124925, v224
    v_mul_f32 v225, 0x3b124925, v225
    v_fma_f32 v225, -v224, v224, v225
    v_max_f32 v225, 0, v225
    v_cvt_pk_bf16_f32 v228, -v224, -v224
    v_cvt_pk_bf16_f32 v225, 0, v225
    v_add_f32 v225, 0x3727c5ac, v225
    v_cvt_pk_bf16_f32 v225, 0, v225
    v_sqrt_f32 v225, v225
    s_nop 0
    v_cvt_pk_bf16_f32 v225, 0, v225
    v_rcp_f32 v231, v225
    s_nop 0
    v_mul_f32 v229, 0xbfb8aa3b, v231
    v_mul_f32 v230, v225, v225
    v_lshlrev_b32 v4, 4, v2
    v_add_u32 v4, 4096, v4
    v_cmp_eq_u32 vcc, 0, v3
    s_and_saveexec_b64 s[62:63], vcc
    ds_write_b128 v4, v[228:231]
    s_mov_b64 exec, -1
    v_mov_b32 v16, 0
    v_mov_b32 v17, 0
    v_mov_b32 v18, 0
    v_mov_b32 v19, 0
    v_mov_b32 v20, 0
    v_mov_b32 v21, 0
    v_mov_b32 v22, 0
    v_mov_b32 v23, 0
    s_mov_b32 s57, 0x3f80
    s_mov_b32 s58, 0x3f800000
    s_waitcnt vmcnt(10)
    v_dot2c_f32_bf16 v16, s57, v44
    v_dot2c_f32_bf16 v17, s58, v44
    v_dot2c_f32_bf16 v18, s57, v45
    v_dot2c_f32_bf16 v19, s58, v45
    v_dot2c_f32_bf16 v20, s57, v46
    v_dot2c_f32_bf16 v21, s58, v46
    v_dot2c_f32_bf16 v22, s57, v47
    v_dot2c_f32_bf16 v23, s58, v47
    v_dot2c_f32_bf16 v16, s57, v48
    v_dot2c_f32_bf16 v17, s58, v48
    v_dot2c_f32_bf16 v18, s57, v49
    v_dot2c_f32_bf16 v19, s58, v49
    v_dot2c_f32_bf16 v20, s57, v50
    v_dot2c_f32_bf16 v21, s58, v50
    v_dot2c_f32_bf16 v22, s57, v51
    v_dot2c_f32_bf16 v23, s58, v51
    v_dot2c_f32_bf16 v16, s57, v52
    v_dot2c_f32_bf16 v17, s58, v52
    v_dot2c_f32_bf16 v18, s57, v53
    v_dot2c_f32_bf16 v19, s58, v53
    v_dot2c_f32_bf16 v20, s57, v54
    v_dot2c_f32_bf16 v21, s58, v54
    v_dot2c_f32_bf16 v22, s57, v55
    v_dot2c_f32_bf16 v23, s58, v55
    v_dot2c_f32_bf16 v16, s57, v56
    v_dot2c_f32_bf16 v17, s58, v56
    v_dot2c_f32_bf16 v18, s57, v57
    v_dot2c_f32_bf16 v19, s58, v57
    v_dot2c_f32_bf16 v20, s57, v58
    v_dot2c_f32_bf16 v21, s58, v58
    v_dot2c_f32_bf16 v22, s57, v59
    v_dot2c_f32_bf16 v23, s58, v59
    s_waitcnt vmcnt(6)
    v_dot2c_f32_bf16 v16, s57, v60
    v_dot2c_f32_bf16 v17, s58, v60
    v_dot2c_f32_bf16 v18, s57, v61
    v_dot2c_f32_bf16 v19, s58, v61
    v_dot2c_f32_bf16 v20, s57, v62
    v_dot2c_f32_bf16 v21, s58, v62
    v_dot2c_f32_bf16 v22, s57, v63
    v_dot2c_f32_bf16 v23, s58, v63
    v_dot2c_f32_bf16 v16, s57, v64
    v_dot2c_f32_bf16 v17, s58, v64
    v_dot2c_f32_bf16 v18, s57, v65
    v_dot2c_f32_bf16 v19, s58, v65
    v_dot2c_f32_bf16 v20, s57, v66
    v_dot2c_f32_bf16 v21, s58, v66
    v_dot2c_f32_bf16 v22, s57, v67
    v_dot2c_f32_bf16 v23, s58, v67
    v_dot2c_f32_bf16 v16, s57, v68
    v_dot2c_f32_bf16 v17, s58, v68
    v_dot2c_f32_bf16 v18, s57, v69
    v_dot2c_f32_bf16 v19, s58, v69
    v_dot2c_f32_bf16 v20, s57, v70
    v_dot2c_f32_bf16 v21, s58, v70
    v_dot2c_f32_bf16 v22, s57, v71
    v_dot2c_f32_bf16 v23, s58, v71
    v_dot2c_f32_bf16 v16, s57, v72
    v_dot2c_f32_bf16 v17, s58, v72
    v_dot2c_f32_bf16 v18, s57, v73
    v_dot2c_f32_bf16 v19, s58, v73
    v_dot2c_f32_bf16 v20, s57, v74
    v_dot2c_f32_bf16 v21, s58, v74
    v_dot2c_f32_bf16 v22, s57, v75
    v_dot2c_f32_bf16 v23, s58, v75
    s_waitcnt vmcnt(2)
    v_dot2c_f32_bf16 v16, s57, v76
    v_dot2c_f32_bf16 v17, s58, v76
    v_dot2c_f32_bf16 v18, s57, v77
    v_dot2c_f32_bf16 v19, s58, v77
    v_dot2c_f32_bf16 v20, s57, v78
    v_dot2c_f32_bf16 v21, s58, v78
    v_dot2c_f32_bf16 v22, s57, v79
    v_dot2c_f32_bf16 v23, s58, v79
    v_dot2c_f32_bf16 v16, s57, v80
    v_dot2c_f32_bf16 v17, s58, v80
    v_dot2c_f32_bf16 v18, s57, v81
    v_dot2c_f32_bf16 v19, s58, v81
    v_dot2c_f32_bf16 v20, s57, v82
    v_dot2c_f32_bf16 v21, s58, v82
    v_dot2c_f32_bf16 v22, s57, v83
    v_dot2c_f32_bf16 v23, s58, v83
    v_dot2c_f32_bf16 v16, s57, v84
    v_dot2c_f32_bf16 v17, s58, v84
    v_dot2c_f32_bf16 v18, s57, v85
    v_dot2c_f32_bf16 v19, s58, v85
    v_dot2c_f32_bf16 v20, s57, v86
    v_dot2c_f32_bf16 v21, s58, v86
    v_dot2c_f32_bf16 v22, s57, v87
    v_dot2c_f32_bf16 v23, s58, v87
    v_dot2c_f32_bf16 v16, s57, v88
    v_dot2c_f32_bf16 v17, s58, v88
    v_dot2c_f32_bf16 v18, s57, v89
    v_dot2c_f32_bf16 v19, s58, v89
    v_dot2c_f32_bf16 v20, s57, v90
    v_dot2c_f32_bf16 v21, s58, v90
    v_dot2c_f32_bf16 v22, s57, v91
    v_dot2c_f32_bf16 v23, s58, v91
    s_waitcnt vmcnt(0)
    v_dot2c_f32_bf16 v16, s57, v92
    v_dot2c_f32_bf16 v17, s58, v92
    v_dot2c_f32_bf16 v18, s57, v93
    v_dot2c_f32_bf16 v19, s58, v93
    v_dot2c_f32_bf16 v20, s57, v94
    v_dot2c_f32_bf16 v21, s58, v94
    v_dot2c_f32_bf16 v22, s57, v95
    v_dot2c_f32_bf16 v23, s58, v95
    v_dot2c_f32_bf16 v16, s57, v96
    v_dot2c_f32_bf16 v17, s58, v96
    v_dot2c_f32_bf16 v18, s57, v97
    v_dot2c_f32_bf16 v19, s58, v97
    v_dot2c_f32_bf16 v20, s57, v98
    v_dot2c_f32_bf16 v21, s58, v98
    v_dot2c_f32_bf16 v22, s57, v99
    v_dot2c_f32_bf16 v23, s58, v99
    s_nop 3
    v_permlane32_swap_b32 v16, v20
    v_permlane32_swap_b32 v17, v21
    v_permlane32_swap_b32 v18, v22
    v_permlane32_swap_b32 v19, v23
    v_add_f32 v16, v16, v20
    v_add_f32 v17, v17, v21
    v_add_f32 v18, v18, v22
    v_add_f32 v19, v19, v23
    s_nop 1
    v_permlane16_swap_b32 v16, v18
    v_permlane16_swap_b32 v17, v19
    v_add_f32 v16, v16, v18
    v_add_f32 v17, v17, v19
    v_and_b32 v4, 15, v1
    v_lshrrev_b32 v5, 4, v1
    v_lshlrev_b32 v4, 5, v4
    v_lshl_add_u32 v4, v5, 3, v4
    s_lshl_b32 s57, s44, 9
    s_add_u32 s57, s57, 0
    v_add_u32 v4, s57, v4
    ds_write_b64 v4, v[16:17]
    s_waitcnt lgkmcnt(0)
    s_barrier
    s_cmp_lg_u32 s44, 0
    s_cbranch_scc1 L_STD
    v_mov_b32 v46, 0
    buffer_load_dwordx2 v[46:47], v46, s[24:27], 0 offen sc1
    v_lshlrev_b32 v4, 4, v1
    ds_read_b128 v[16:19], v4 offset:4096
    v_lshlrev_b32 v5, 3, v1
    ds_read_b64 v[20:21], v5 offset:0
    ds_read_b64 v[22:23], v5 offset:512
    ds_read_b64 v[24:25], v5 offset:1024
    ds_read_b64 v[26:27], v5 offset:1536
    ds_read_b64 v[28:29], v5 offset:2048
    ds_read_b64 v[30:31], v5 offset:2560
    ds_read_b64 v[32:33], v5 offset:3072
    ds_read_b64 v[34:35], v5 offset:3584
    s_lshl_b32 s57, s2, 10
    s_add_u32 s57, s57, 12582912
    s_waitcnt lgkmcnt(0)
    buffer_store_dwordx4 v[16:19], v4, s[16:19], s57 offen sc1
    v_add_f32 v20, v20, v22
    v_add_f32 v24, v24, v26
    v_add_f32 v28, v28, v30
    v_add_f32 v32, v32, v34
    v_add_f32 v20, v20, v24
    v_add_f32 v28, v28, v32
    v_add_f32 v20, v20, v28
    v_cvt_pk_bf16_f32 v36, 0, v20
    v_sub_f32 v37, v20, v36
    v_cvt_pk_bf16_f32 v38, 0, v37
    v_sub_f32 v37, v37, v38
    v_cvt_pk_bf16_f32 v40, v36, v38
    v_cvt_pk_bf16_f32 v41, v37, 0
    v_add_f32 v21, v21, v23
    v_add_f32 v25, v25, v27
    v_add_f32 v29, v29, v31
    v_add_f32 v33, v33, v35
    v_add_f32 v21, v21, v25
    v_add_f32 v29, v29, v33
    v_add_f32 v21, v21, v29
    v_cvt_pk_bf16_f32 v36, 0, v21
    v_sub_f32 v37, v21, v36
    v_cvt_pk_bf16_f32 v38, 0, v37
    v_sub_f32 v37, v37, v38
    v_cvt_pk_bf16_f32 v42, v36, v38
    v_cvt_pk_bf16_f32 v43, v37, 0
    s_mul_i32 s57, s2, 896
    s_add_u32 s57, s57, 12648448
    s_mov_b32 exec_lo, -1
    s_mov_b32 exec_hi, 0xffffff
    buffer_store_dwordx4 v[40:43], v4, s[16:19], s57 offen sc1
    s_mov_b64 exec, -1
    s_waitcnt vmcnt(0)
    v_readfirstlane_b32 s78, v46
    v_readfirstlane_b32 s79, v47
    s_nop 3
    s_cmp_lg_u32 s79, 0
    s_cbranch_scc1 L_OK_35
    s_mov_b32 s67, 0
L_SPIN_36:
    s_sleep 1
    v_mov_b32 v46, 0
    buffer_load_dwordx2 v[46:47], v46, s[24:27], 0 offen sc1
    s_waitcnt vmcnt(0)
    v_readfirstlane_b32 s78, v46
    v_readfirstlane_b32 s79, v47
    s_nop 3
    s_cmp_lg_u32 s79, 0
    s_cbranch_scc1 L_OK_35
    s_add_u32 s67, s67, 1
    s_cmp_lt_u32 s67, 200000
    s_cbranch_scc1 L_SPIN_36
L_OK_35:
    s_mov_b32 s57, 14170112
    v_mov_b32 v48, v46
    v_mov_b32 v49, v47
    v_mov_b32 v5, s2
    v_lshlrev_b32 v5, 6, v5
    s_mov_b64 exec, 1
    buffer_store_dwordx4 v[46:49], v5, s[16:19], s57 offen sc1
    s_mov_b64 exec, -1
    s_waitcnt vmcnt(0)
L_STD:
    s_barrier
    s_mov_b32 s28, s72
    s_and_b32 s29, s73, 0xffff
    s_mov_b32 s30, 1835008
    s_mov_b32 s31, 0x20000
    s_mov_b32 s12, s82
    s_and_b32 s13, s83, 0xffff
    s_mov_b32 s14, 1605632
    s_mov_b32 s15, 0x20000
    s_lshl_b32 s60, s2, 3
    s_add_u32 s60, s60, s44
    s_mul_i32 s60, s60, 7168
    v_lshlrev_b32 v8, 4, v1
    s_add_u32 s57, s60, 0
    buffer_load_dwordx4 v[100:103], v8, s[12:15], s57 offen
    buffer_load_dwordx4 v[104:107], v8, s[28:31], s57 offen
    s_add_u32 s57, s60, 1024
    buffer_load_dwordx4 v[108:111], v8, s[12:15], s57 offen
    buffer_load_dwordx4 v[112:115], v8, s[28:31], s57 offen
    s_add_u32 s57, s60, 2048
    buffer_load_dwordx4 v[116:119], v8, s[12:15], s57 offen
    buffer_load_dwordx4 v[120:123], v8, s[28:31], s57 offen
    s_add_u32 s57, s60, 3072
    buffer_load_dwordx4 v[124:127], v8, s[12:15], s57 offen
    buffer_load_dwordx4 v[128:131], v8, s[28:31], s57 offen
    s_add_u32 s57, s60, 4096
    buffer_load_dwordx4 v[132:135], v8, s[12:15], s57 offen
    buffer_load_dwordx4 v[136:139], v8, s[28:31], s57 offen
    s_add_u32 s57, s60, 5120
    buffer_load_dwordx4 v[140:143], v8, s[12:15], s57 offen
    buffer_load_dwordx4 v[144:147], v8, s[28:31], s57 offen
    s_add_u32 s57, s60, 6144
    buffer_load_dwordx4 v[148:151], v8, s[12:15], s57 offen
    buffer_load_dwordx4 v[152:155], v8, s[28:31], s57 offen
L_END:
    s_endpgm
L_CODE_END:
.section .rodata,"a"
.p2align 6
.amdhsa_kernel recurrent_scan__ssm_conv_h3__glu_gated_swiglu__prompt_kernel
  .amdhsa_next_free_vgpr 256
  .amdhsa_next_free_sgpr 102
  .amdhsa_accum_offset 256
  .amdhsa_group_segment_fixed_size 0
  .amdhsa_kernarg_size 104
  .amdhsa_user_sgpr_count 2
  .amdhsa_user_sgpr_kernarg_segment_ptr 1
  .amdhsa_system_sgpr_workgroup_id_x 1
.end_amdhsa_kernel
```
